```python
import torch

def _softmax(x, axis=-1):
    return torch.softmax(x, dim=axis)

def _gelu(x):
    return torch.nn.functional.gelu(x, approximate='tanh')

def _silu(x):
    return torch.nn.functional.silu(x)

def _sigmoid(x):
    return torch.sigmoid(x)

def _layernorm(x, axis=-1, eps=1e-05):
    m = x.mean(dim=axis, keepdim=True)
    v = x.var(dim=axis, keepdim=True, unbiased=False)
    return (x - m) / torch.sqrt(v + eps)

def _scatter_add(tgt, idx, src, axis=0):
    return tgt.clone().index_add_(axis, idx, src)

def _segment_sum(src, seg, n):
    out = torch.zeros((n,) + src.shape[1:], dtype=src.dtype)
    return out.index_add_(0, seg, src)

def _pad(x, pw):
    flat = tuple((v for pair in reversed(pw) for v in pair))
    return torch.nn.functional.pad(x, flat)
kernel_name = 'standalone__tree_speculative_verify_tree_attention_over_candidate_token_tree__sampling'

def setup_inputs():

    _w = lambda a: (lambda t: t.to(torch.bfloat16) if t.is_floating_point() else t)(torch.as_tensor(a))
    B, Hq, Hkv, T, C, D = (16, 16, 8, 16, 4096, 256)
    tree_mask = torch.zeros((B, T, T), dtype=float)
    for b in range(B):
        parent = torch.zeros(T, dtype=torch.int64)
        for i in range(1, T):
            parent[i] = int(torch.randint(0, i, (1,)).item())
        for i in range(T):
            j = i
            tree_mask[b, i, j] = 1.0
            while j > 0:
                j = parent[j]
                tree_mask[b, i, j] = 1.0
    return {'q': _w((lambda *s: torch.randn(*s, dtype=torch.bfloat16) * 0.8)(B, Hq, T, D)), 'k_cache': _w((lambda *s: torch.randn(*s, dtype=torch.bfloat16) * 0.8)(B, Hkv, C, D)), 'v_cache': _w((lambda *s: torch.randn(*s, dtype=torch.bfloat16) * 0.05)(B, Hkv, C, D)), 'k_tree': _w((lambda *s: torch.randn(*s, dtype=torch.bfloat16) * 0.8)(B, Hkv, T, D)), 'v_tree': _w((lambda *s: torch.randn(*s, dtype=torch.bfloat16) * 0.05)(B, Hkv, T, D)), 'tree_mask': _w(tree_mask)}

def reference(q, k_cache, v_cache, k_tree, v_tree, tree_mask):
    B, Hq, T, D = q.shape
    Hkv, C = (k_cache.shape[1], k_cache.shape[2])
    rep = Hq // Hkv
    kc = (lambda x, n, axis: torch.repeat_interleave(x, n, dim=axis))(k_cache, rep, axis=1)
    vc = (lambda x, n, axis: torch.repeat_interleave(x, n, dim=axis))(v_cache, rep, axis=1)
    kt = (lambda x, n, axis: torch.repeat_interleave(x, n, dim=axis))(k_tree, rep, axis=1)
    vt = (lambda x, n, axis: torch.repeat_interleave(x, n, dim=axis))(v_tree, rep, axis=1)
    k = torch.concatenate([kc, kt], axis=2)
    v = torch.concatenate([vc, vt], axis=2)
    scale = D ** (-0.5)
    scores = torch.einsum('bhqd,bhkd->bhqk', q, k) * scale
    ctx_mask = torch.ones((B, 1, T, C), dtype=scores.dtype)
    tm = tree_mask[:, None, :, :].clone()
    full_mask = torch.concatenate([ctx_mask, tm], axis=-1)
    scores = scores + (1.0 - full_mask) * -1000000000.0
    p = _softmax(scores, axis=-1)
    return torch.einsum('bhqk,bhkd->bhqd', p, v)
```

```asm
; @launch grid=(256,1,1) block=(256,1,1) lds=163840
.amdgcn_target "amdgcn-amd-amdhsa--gfx950"
.text
.globl standalone__tree_speculative_verify_tree_attention_over_candidate_token_tree__sampling_kernel
.p2align 8
.type standalone__tree_speculative_verify_tree_attention_over_candidate_token_tree__sampling_kernel,@function
standalone__tree_speculative_verify_tree_attention_over_candidate_token_tree__sampling_kernel:
  s_cmp_ge_u32 s2, 256
  s_cbranch_scc1 L_end
  s_load_dwordx16 s[4:19], s[0:1], 0
  s_load_dwordx2 s[20:21], s[0:1], 64
  v_lshrrev_b32 v2, 6, v0
  v_and_b32 v1, 63, v0
  v_readfirstlane_b32 s3, v2
  v_lshlrev_b32 v5, 2, v0
  v_add_u32 v5, 98304, v5
  v_mov_b32 v6, 0
  ds_write_b32 v5, v6
  v_lshrrev_b32 v2, 5, v1
  v_and_b32 v3, 31, v1
  v_lshlrev_b32 v4, 2, v2
  v_xor_b32 v4, v3, v4
  v_lshlrev_b32 v4, 4, v4
  v_lshl_add_u32 v10, v2, 9, v4
  v_xor_b32 v11, 128, v10
  v_xor_b32 v12, 16, v10
  v_xor_b32 v13, 144, v10
  v_xor_b32 v14, 32, v10
  v_xor_b32 v15, 160, v10
  v_xor_b32 v16, 48, v10
  v_xor_b32 v17, 176, v10
  s_and_b32 s22, s2, 7
  s_lshr_b32 s53, s2, 4
  s_lshl_b32 s53, s53, 3
  s_or_b32 s22, s22, s53
  s_lshr_b32 s23, s2, 3
  s_and_b32 s23, s23, 1
  s_mov_b32 s40, 4096
  s_mov_b32 s41, 8192
  s_mov_b32 s42, 12288
  s_lshl_b32 s56, s22, 21
  s_mov_b32 s26, 16384
  s_mov_b32 s27, 0x20000
  s_mov_b32 s30, 16384
  s_mov_b32 s31, 0x20000
  s_mov_b64 s[32:33], 0
  s_mov_b32 s34, 0
  s_mov_b32 s35, 0x20000
  s_mov_b64 s[36:37], 0
  s_mov_b32 s38, 0
  s_mov_b32 s39, 0x20000
  s_mov_b64 s[92:93], 0
  s_mov_b32 s94, 0
  s_mov_b32 s95, 0x20000
  v_mov_b32 v104, 0
  v_mov_b32 v105, 0
  v_mov_b32 v108, 0
  s_lshl_b32 s43, s3, 15
  s_mul_i32 s76, s23, 2080768
  s_and_b32 s88, s22, 1
  s_lshl_b32 s88, s88, 4
  s_lshr_b32 s57, s22, 1
  s_lshl_b32 s57, s57, 2
  s_mov_b32 s48, 0
  s_mov_b32 s45, 0
  s_mov_b32 s47, 0
  s_mov_b32 s46, 0
  s_mov_b32 s44, 0
  v_mov_b32 v92, 98304
  v_mov_b32 v93, 0
  v_mov_b32 v94, 98368
  s_cmp_eq_u32 s23, 0
  s_cselect_b32 s77, 1, -1
  s_cselect_b32 s49, 64, 64
  s_cselect_b32 s78, 0, 0
  s_cselect_b32 s79, 1, 1
  s_cselect_b32 s81, 2, 2
  s_cselect_b32 s58, 21, 21
  s_mul_i32 s77, s77, 16384
  s_waitcnt lgkmcnt(0)
  s_barrier
  s_add_u32 s82, s6, s56
  s_addc_u32 s83, s7, 0
  s_add_u32 s84, s8, s56
  s_addc_u32 s85, s9, 0
  s_add_u32 s96, s18, s57
  s_addc_u32 s97, s19, 0
  s_cmp_lg_u32 s3, 3
  s_cbranch_scc1 L_consumer
L_ld_loop:
  s_add_u32 s24, s82, s76
  s_addc_u32 s25, s83, 0
  s_add_u32 s28, s84, s76
  s_addc_u32 s29, s85, 0
  s_cmp_eq_u32 s46, 0
  s_cbranch_scc1 L_free_a
L_spin_a:
  ds_read2_b32 v[96:97], v94 offset0:0 offset1:2
  s_waitcnt lgkmcnt(0)
  v_min_u32 v95, v96, v97
  s_nop 0
  v_readfirstlane_b32 s53, v95
  s_nop 0
  s_cmp_ge_u32 s53, s46
  s_cbranch_scc0 L_spin_a
L_free_a:
  s_add_u32 s53, s45, 1
  s_cmp_eq_u32 s53, s49
  s_cbranch_scc0 L_noticket_a
  s_lshl_b32 s99, 1, s88
  s_atomic_add s99, s[96:97], 0x0 glc
L_noticket_a:
  s_add_u32 m0, s44, 0
  s_waitcnt vmcnt(19)
  buffer_load_dwordx4 v10, s[24:27], 0 offen offset:0 nt lds
  s_waitcnt vmcnt(19)
  buffer_load_dwordx4 v11, s[24:27], 0 offen offset:1024 nt lds
  s_waitcnt vmcnt(19)
  buffer_load_dwordx4 v12, s[24:27], 0 offen offset:2048 nt lds
  s_waitcnt vmcnt(19)
  buffer_load_dwordx4 v13, s[24:27], 0 offen offset:3072 nt lds
  s_cmp_eq_u32 s45, 0
  s_cbranch_scc1 L_nopub_a0
  s_mov_b64 exec, 1
  ds_write_b32 v92, v93 offset:0
  s_mov_b64 exec, -1
L_nopub_a0:
  s_add_u32 m0, s44, 4096
  s_waitcnt vmcnt(19)
  buffer_load_dwordx4 v14, s[24:27], s40 offen offset:0 nt lds
  s_waitcnt vmcnt(19)
  buffer_load_dwordx4 v15, s[24:27], s40 offen offset:1024 nt lds
  s_waitcnt vmcnt(19)
  buffer_load_dwordx4 v16, s[24:27], s40 offen offset:2048 nt lds
  s_waitcnt vmcnt(19)
  buffer_load_dwordx4 v17, s[24:27], s40 offen offset:3072 nt lds
  s_add_u32 m0, s44, 8192
  s_waitcnt vmcnt(19)
  buffer_load_dwordx4 v10, s[24:27], s41 offen offset:0 nt lds
  s_waitcnt vmcnt(19)
  buffer_load_dwordx4 v11, s[24:27], s41 offen offset:1024 nt lds
  s_waitcnt vmcnt(19)
  buffer_load_dwordx4 v12, s[24:27], s41 offen offset:2048 nt lds
  s_waitcnt vmcnt(19)
  buffer_load_dwordx4 v13, s[24:27], s41 offen offset:3072 nt lds
  s_add_u32 m0, s44, 12288
  s_waitcnt vmcnt(19)
  buffer_load_dwordx4 v14, s[24:27], s42 offen offset:0 nt lds
  s_waitcnt vmcnt(19)
  buffer_load_dwordx4 v15, s[24:27], s42 offen offset:1024 nt lds
  s_waitcnt vmcnt(19)
  buffer_load_dwordx4 v16, s[24:27], s42 offen offset:2048 nt lds
  s_waitcnt vmcnt(19)
  buffer_load_dwordx4 v17, s[24:27], s42 offen offset:3072 nt lds
  s_add_u32 m0, s44, 16384
  s_waitcnt vmcnt(19)
  buffer_load_dwordx4 v10, s[28:31], 0 offen offset:0 nt lds
  s_waitcnt vmcnt(19)
  buffer_load_dwordx4 v11, s[28:31], 0 offen offset:1024 nt lds
  s_waitcnt vmcnt(19)
  buffer_load_dwordx4 v12, s[28:31], 0 offen offset:2048 nt lds
  s_waitcnt vmcnt(19)
  buffer_load_dwordx4 v13, s[28:31], 0 offen offset:3072 nt lds
  s_cmp_eq_u32 s45, 0
  s_cbranch_scc1 L_nopub_a1
  s_mov_b64 exec, 1
  ds_write_b32 v92, v93 offset:8
  s_mov_b64 exec, -1
L_nopub_a1:
  s_add_u32 m0, s44, 20480
  s_cmp_eq_u32 s45, 0
  s_cbranch_scc0 L_no_setup
  v_lshlrev_b32 v104, 3, v1
  v_lshlrev_b32 v105, 4, v1
  s_cmp_eq_u32 s3, s78
  s_cselect_b32 s53, 98304, s43
  v_add_u32 v106, s53, v105
  s_lshl_b32 s53, s3, 9
  s_add_u32 s53, s53, 100352
  v_add_u32 v107, s53, v104
  v_mov_b32 v109, 98448
  v_add_u32 v110, 102400, v105
  v_add_u32 v111, 101888, v104
  v_lshrrev_b32 v4, 5, v1
  v_bfe_u32 v2, v1, 4, 1
  v_bfe_u32 v3, v1, 1, 1
  v_lshl_or_b32 v2, v2, 1, v3
  v_bfe_u32 v3, v1, 2, 2
  v_lshl_or_b32 v5, v3, 2, v4
  v_xor_b32 v2, v2, v5
  v_lshlrev_b32 v2, 4, v2
  v_lshl_add_u32 v3, v4, 2, v3
  v_lshl_add_u32 v2, v3, 9, v2
  v_and_b32 v3, 1, v1
  v_lshl_add_u32 v2, v3, 3, v2
  s_lshl_b32 s53, s3, 7
  v_xor_b32 v2, s53, v2
  s_lshl_b32 s53, s78, 15
  s_add_u32 s53, s53, 16384
  v_add_u32 v112, s53, v2
  v_xor_b32 v113, 32, v112
  v_xor_b32 v114, 64, v112
  v_xor_b32 v115, 96, v112
  s_xor_b32 s54, s23, 0
  s_lshl_b32 s53, s22, 1
  s_add_u32 s54, s53, s54
  s_lshl_b32 s54, s54, 2
  s_add_u32 s54, s54, s3
  s_mul_i32 s54, s54, 8704
  s_add_u32 s32, s20, s54
  s_addc_u32 s33, s21, 0
  s_mov_b32 s34, 8704
  s_mov_b32 s35, 0x20000
  s_xor_b32 s54, s23, 1
  s_lshl_b32 s53, s22, 1
  s_add_u32 s54, s53, s54
  s_lshl_b32 s54, s54, 2
  s_add_u32 s54, s54, s3
  s_mul_i32 s54, s54, 8704
  s_add_u32 s36, s20, s54
  s_addc_u32 s37, s21, 0
  s_mov_b32 s38, 8704
  s_mov_b32 s39, 0x20000
  s_lshl_b32 s53, s22, 14
  s_add_u32 s92, s16, s53
  s_addc_u32 s93, s17, 0
  s_mov_b32 s94, 16384
  s_mov_b32 s95, 0x20000
  v_and_b32 v108, 31, v1
  v_lshlrev_b32 v108, 9, v108
  v_lshrrev_b32 v2, 5, v1
  v_lshl_add_u32 v108, v2, 4, v108
  s_lshl_b32 s53, s3, 7
  v_add_u32 v108, s53, v108
L_no_setup:
  s_waitcnt vmcnt(19)
  buffer_load_dwordx4 v14, s[28:31], s40 offen offset:0 nt lds
  s_waitcnt vmcnt(19)
  buffer_load_dwordx4 v15, s[28:31], s40 offen offset:1024 nt lds
  s_waitcnt vmcnt(19)
  buffer_load_dwordx4 v16, s[28:31], s40 offen offset:2048 nt lds
  s_waitcnt vmcnt(19)
  buffer_load_dwordx4 v17, s[28:31], s40 offen offset:3072 nt lds
  s_add_u32 m0, s44, 24576
  s_waitcnt vmcnt(19)
  buffer_load_dwordx4 v10, s[28:31], s41 offen offset:0 nt lds
  s_waitcnt vmcnt(19)
  buffer_load_dwordx4 v11, s[28:31], s41 offen offset:1024 nt lds
  s_waitcnt vmcnt(19)
  buffer_load_dwordx4 v12, s[28:31], s41 offen offset:2048 nt lds
  s_waitcnt vmcnt(19)
  buffer_load_dwordx4 v13, s[28:31], s41 offen offset:3072 nt lds
  s_add_u32 m0, s44, 28672
  s_waitcnt vmcnt(19)
  buffer_load_dwordx4 v14, s[28:31], s42 offen offset:0 nt lds
  s_waitcnt vmcnt(19)
  buffer_load_dwordx4 v15, s[28:31], s42 offen offset:1024 nt lds
  s_waitcnt vmcnt(19)
  buffer_load_dwordx4 v16, s[28:31], s42 offen offset:2048 nt lds
  s_waitcnt vmcnt(19)
  buffer_load_dwordx4 v17, s[28:31], s42 offen offset:3072 nt lds
  s_lshl_b32 s53, s47, 4
  s_add_u32 s53, s53, 98304
  v_mov_b32 v92, s53
  s_add_u32 s53, s46, 1
  v_mov_b32 v93, s53
  s_add_u32 s47, s47, 1
  s_add_u32 s44, s44, 32768
  s_cmp_lt_u32 s47, 3
  s_cbranch_scc1 L_ld_same
  s_mov_b32 s47, 0
  s_mov_b32 s44, 0
  s_add_u32 s46, s46, 1
L_ld_same:
  s_lshl_b32 s53, s47, 4
  s_add_u32 s53, s53, 98368
  v_mov_b32 v94, s53
  s_add_u32 s45, s45, 1
  s_add_u32 s76, s76, s77
  s_cmp_lt_u32 s45, s49
  s_cbranch_scc1 L_ld_loop
  s_waitcnt vmcnt(16)
  s_mov_b64 exec, 1
  ds_write_b32 v92, v93 offset:0
  s_mov_b64 exec, -1
  v_mov_b32 v42, 0xff800000
  v_mov_b32 v43, 0
  v_mov_b32 v128, 0
  v_mov_b32 v129, 0
  v_mov_b32 v130, 0
  v_mov_b32 v131, 0
  v_mov_b32 v132, 0
  v_mov_b32 v133, 0
  v_mov_b32 v134, 0
  v_mov_b32 v135, 0
  v_mov_b32 v136, 0
  v_mov_b32 v137, 0
  v_mov_b32 v138, 0
  v_mov_b32 v139, 0
  v_mov_b32 v140, 0
  v_mov_b32 v141, 0
  v_mov_b32 v142, 0
  v_mov_b32 v143, 0
  v_mov_b32 v144, 0
  v_mov_b32 v145, 0
  v_mov_b32 v146, 0
  v_mov_b32 v147, 0
  v_mov_b32 v148, 0
  v_mov_b32 v149, 0
  v_mov_b32 v150, 0
  v_mov_b32 v151, 0
  v_mov_b32 v152, 0
  v_mov_b32 v153, 0
  v_mov_b32 v154, 0
  v_mov_b32 v155, 0
  v_mov_b32 v156, 0
  v_mov_b32 v157, 0
  v_mov_b32 v158, 0
  v_mov_b32 v159, 0
  s_waitcnt lgkmcnt(0)
  s_lshr_b32 s99, s99, s88
  s_and_b32 s54, s99, 3
  s_add_u32 s54, s54, 1
  s_bfe_u32 s55, s99, 65540
  v_mov_b32 v96, s54
  v_mov_b32 v97, s55
  s_mov_b64 exec, 1
  ds_write2_b32 v109, v96, v97 offset0:0 offset1:2
  s_mov_b64 exec, -1
  s_cmp_eq_u32 s3, s78
  s_cbranch_scc1 L_nomerge_l1
  s_lshl_b32 s54, s78, 2
  s_add_u32 s54, s54, 98480
  v_mov_b32 v116, s54
  s_xor_b32 s54, s3, s78
  s_lshl_b32 s54, s54, 13
  s_add_u32 s54, s54, 98304
  v_add_u32 v117, s54, v105
  s_lshl_b32 s55, s78, 9
  s_add_u32 s55, s55, 100352
L_w_done_l1:
  ds_read_b32 v95, v116 offset:0
  s_waitcnt lgkmcnt(0)
  v_readfirstlane_b32 s53, v95
  s_nop 0
  s_cmp_lg_u32 s53, 0
  s_cbranch_scc0 L_w_done_l1
  v_add_u32 v116, s55, v104
  ds_read_b64 v[102:103], v116
  ds_read_b128 v[160:163], v117 offset:0
  ds_read_b128 v[164:167], v117 offset:1024
  ds_read_b128 v[168:171], v117 offset:2048
  ds_read_b128 v[172:175], v117 offset:3072
  ds_read_b128 v[176:179], v117 offset:4096
  ds_read_b128 v[180:183], v117 offset:5120
  ds_read_b128 v[184:187], v117 offset:6144
  ds_read_b128 v[188:191], v117 offset:7168
  s_waitcnt lgkmcnt(8)
  v_max_f32 v45, v42, v102
  v_sub_f32 v98, v42, v45
  v_sub_f32 v100, v102, v45
  v_exp_f32 v98, v98
  v_exp_f32 v100, v100
  v_mov_b32 v42, v45
  v_mul_f32 v43, v43, v98
  v_fma_f32 v43, v103, v100, v43
  v_pk_mul_f32 v[128:129], v[128:129], v[98:99] op_sel_hi:[1,0]
  v_pk_mul_f32 v[130:131], v[130:131], v[98:99] op_sel_hi:[1,0]
  v_pk_mul_f32 v[132:133], v[132:133], v[98:99] op_sel_hi:[1,0]
  v_pk_mul_f32 v[134:135], v[134:135], v[98:99] op_sel_hi:[1,0]
  v_pk_mul_f32 v[136:137], v[136:137], v[98:99] op_sel_hi:[1,0]
  v_pk_mul_f32 v[138:139], v[138:139], v[98:99] op_sel_hi:[1,0]
  v_pk_mul_f32 v[140:141], v[140:141], v[98:99] op_sel_hi:[1,0]
  v_pk_mul_f32 v[142:143], v[142:143], v[98:99] op_sel_hi:[1,0]
  v_pk_mul_f32 v[144:145], v[144:145], v[98:99] op_sel_hi:[1,0]
  v_pk_mul_f32 v[146:147], v[146:147], v[98:99] op_sel_hi:[1,0]
  v_pk_mul_f32 v[148:149], v[148:149], v[98:99] op_sel_hi:[1,0]
  v_pk_mul_f32 v[150:151], v[150:151], v[98:99] op_sel_hi:[1,0]
  v_pk_mul_f32 v[152:153], v[152:153], v[98:99] op_sel_hi:[1,0]
  v_pk_mul_f32 v[154:155], v[154:155], v[98:99] op_sel_hi:[1,0]
  v_pk_mul_f32 v[156:157], v[156:157], v[98:99] op_sel_hi:[1,0]
  v_pk_mul_f32 v[158:159], v[158:159], v[98:99] op_sel_hi:[1,0]
  s_waitcnt lgkmcnt(0)
  v_pk_fma_f32 v[128:129], v[160:161], v[100:101], v[128:129] op_sel_hi:[1,0,1]
  v_pk_fma_f32 v[130:131], v[162:163], v[100:101], v[130:131] op_sel_hi:[1,0,1]
  v_pk_fma_f32 v[132:133], v[164:165], v[100:101], v[132:133] op_sel_hi:[1,0,1]
  v_pk_fma_f32 v[134:135], v[166:167], v[100:101], v[134:135] op_sel_hi:[1,0,1]
  v_pk_fma_f32 v[136:137], v[168:169], v[100:101], v[136:137] op_sel_hi:[1,0,1]
  v_pk_fma_f32 v[138:139], v[170:171], v[100:101], v[138:139] op_sel_hi:[1,0,1]
  v_pk_fma_f32 v[140:141], v[172:173], v[100:101], v[140:141] op_sel_hi:[1,0,1]
  v_pk_fma_f32 v[142:143], v[174:175], v[100:101], v[142:143] op_sel_hi:[1,0,1]
  v_pk_fma_f32 v[144:145], v[176:177], v[100:101], v[144:145] op_sel_hi:[1,0,1]
  v_pk_fma_f32 v[146:147], v[178:179], v[100:101], v[146:147] op_sel_hi:[1,0,1]
  v_pk_fma_f32 v[148:149], v[180:181], v[100:101], v[148:149] op_sel_hi:[1,0,1]
  v_pk_fma_f32 v[150:151], v[182:183], v[100:101], v[150:151] op_sel_hi:[1,0,1]
  v_pk_fma_f32 v[152:153], v[184:185], v[100:101], v[152:153] op_sel_hi:[1,0,1]
  v_pk_fma_f32 v[154:155], v[186:187], v[100:101], v[154:155] op_sel_hi:[1,0,1]
  v_pk_fma_f32 v[156:157], v[188:189], v[100:101], v[156:157] op_sel_hi:[1,0,1]
  v_pk_fma_f32 v[158:159], v[190:191], v[100:101], v[158:159] op_sel_hi:[1,0,1]
L_nomerge_l1:
  s_cmp_eq_u32 s3, s79
  s_cbranch_scc1 L_nomerge_l2
  s_lshl_b32 s54, s79, 2
  s_add_u32 s54, s54, 98480
  v_mov_b32 v116, s54
  s_xor_b32 s54, s3, s79
  s_lshl_b32 s54, s54, 13
  s_lshl_b32 s55, s79, 15
  s_add_u32 s54, s54, s55
  v_add_u32 v117, s54, v105
  s_lshl_b32 s55, s79, 9
  s_add_u32 s55, s55, 100352
L_w_done_l2:
  ds_read_b32 v95, v116 offset:0
  s_waitcnt lgkmcnt(0)
  v_readfirstlane_b32 s53, v95
  s_nop 0
  s_cmp_lg_u32 s53, 0
  s_cbranch_scc0 L_w_done_l2
  v_add_u32 v116, s55, v104
  ds_read_b64 v[102:103], v116
  ds_read_b128 v[160:163], v117 offset:0
  ds_read_b128 v[164:167], v117 offset:1024
  ds_read_b128 v[168:171], v117 offset:2048
  ds_read_b128 v[172:175], v117 offset:3072
  ds_read_b128 v[176:179], v117 offset:4096
  ds_read_b128 v[180:183], v117 offset:5120
  ds_read_b128 v[184:187], v117 offset:6144
  ds_read_b128 v[188:191], v117 offset:7168
  s_waitcnt lgkmcnt(8)
  v_max_f32 v45, v42, v102
  v_sub_f32 v98, v42, v45
  v_sub_f32 v100, v102, v45
  v_exp_f32 v98, v98
  v_exp_f32 v100, v100
  v_mov_b32 v42, v45
  v_mul_f32 v43, v43, v98
  v_fma_f32 v43, v103, v100, v43
  v_pk_mul_f32 v[128:129], v[128:129], v[98:99] op_sel_hi:[1,0]
  v_pk_mul_f32 v[130:131], v[130:131], v[98:99] op_sel_hi:[1,0]
  v_pk_mul_f32 v[132:133], v[132:133], v[98:99] op_sel_hi:[1,0]
  v_pk_mul_f32 v[134:135], v[134:135], v[98:99] op_sel_hi:[1,0]
  v_pk_mul_f32 v[136:137], v[136:137], v[98:99] op_sel_hi:[1,0]
  v_pk_mul_f32 v[138:139], v[138:139], v[98:99] op_sel_hi:[1,0]
  v_pk_mul_f32 v[140:141], v[140:141], v[98:99] op_sel_hi:[1,0]
  v_pk_mul_f32 v[142:143], v[142:143], v[98:99] op_sel_hi:[1,0]
  v_pk_mul_f32 v[144:145], v[144:145], v[98:99] op_sel_hi:[1,0]
  v_pk_mul_f32 v[146:147], v[146:147], v[98:99] op_sel_hi:[1,0]
  v_pk_mul_f32 v[148:149], v[148:149], v[98:99] op_sel_hi:[1,0]
  v_pk_mul_f32 v[150:151], v[150:151], v[98:99] op_sel_hi:[1,0]
  v_pk_mul_f32 v[152:153], v[152:153], v[98:99] op_sel_hi:[1,0]
  v_pk_mul_f32 v[154:155], v[154:155], v[98:99] op_sel_hi:[1,0]
  v_pk_mul_f32 v[156:157], v[156:157], v[98:99] op_sel_hi:[1,0]
  v_pk_mul_f32 v[158:159], v[158:159], v[98:99] op_sel_hi:[1,0]
  s_waitcnt lgkmcnt(0)
  v_pk_fma_f32 v[128:129], v[160:161], v[100:101], v[128:129] op_sel_hi:[1,0,1]
  v_pk_fma_f32 v[130:131], v[162:163], v[100:101], v[130:131] op_sel_hi:[1,0,1]
  v_pk_fma_f32 v[132:133], v[164:165], v[100:101], v[132:133] op_sel_hi:[1,0,1]
  v_pk_fma_f32 v[134:135], v[166:167], v[100:101], v[134:135] op_sel_hi:[1,0,1]
  v_pk_fma_f32 v[136:137], v[168:169], v[100:101], v[136:137] op_sel_hi:[1,0,1]
  v_pk_fma_f32 v[138:139], v[170:171], v[100:101], v[138:139] op_sel_hi:[1,0,1]
  v_pk_fma_f32 v[140:141], v[172:173], v[100:101], v[140:141] op_sel_hi:[1,0,1]
  v_pk_fma_f32 v[142:143], v[174:175], v[100:101], v[142:143] op_sel_hi:[1,0,1]
  v_pk_fma_f32 v[144:145], v[176:177], v[100:101], v[144:145] op_sel_hi:[1,0,1]
  v_pk_fma_f32 v[146:147], v[178:179], v[100:101], v[146:147] op_sel_hi:[1,0,1]
  v_pk_fma_f32 v[148:149], v[180:181], v[100:101], v[148:149] op_sel_hi:[1,0,1]
  v_pk_fma_f32 v[150:151], v[182:183], v[100:101], v[150:151] op_sel_hi:[1,0,1]
  v_pk_fma_f32 v[152:153], v[184:185], v[100:101], v[152:153] op_sel_hi:[1,0,1]
  v_pk_fma_f32 v[154:155], v[186:187], v[100:101], v[154:155] op_sel_hi:[1,0,1]
  v_pk_fma_f32 v[156:157], v[188:189], v[100:101], v[156:157] op_sel_hi:[1,0,1]
  v_pk_fma_f32 v[158:159], v[190:191], v[100:101], v[158:159] op_sel_hi:[1,0,1]
L_nomerge_l2:
  s_cmp_eq_u32 s3, s81
  s_cbranch_scc1 L_nomerge_l3
  s_lshl_b32 s54, s81, 2
  s_add_u32 s54, s54, 98480
  v_mov_b32 v116, s54
  s_xor_b32 s54, s3, s81
  s_lshl_b32 s54, s54, 13
  s_lshl_b32 s55, s81, 15
  s_add_u32 s54, s54, s55
  v_add_u32 v117, s54, v105
  s_lshl_b32 s55, s81, 9
  s_add_u32 s55, s55, 100352
L_w_done_l3:
  ds_read_b32 v95, v116 offset:0
  s_waitcnt lgkmcnt(0)
  v_readfirstlane_b32 s53, v95
  s_nop 0
  s_cmp_lg_u32 s53, 0
  s_cbranch_scc0 L_w_done_l3
  v_add_u32 v116, s55, v104
  ds_read_b64 v[102:103], v116
  ds_read_b128 v[160:163], v117 offset:0
  ds_read_b128 v[164:167], v117 offset:1024
  ds_read_b128 v[168:171], v117 offset:2048
  ds_read_b128 v[172:175], v117 offset:3072
  ds_read_b128 v[176:179], v117 offset:4096
  ds_read_b128 v[180:183], v117 offset:5120
  ds_read_b128 v[184:187], v117 offset:6144
  ds_read_b128 v[188:191], v117 offset:7168
  s_waitcnt lgkmcnt(8)
  v_max_f32 v45, v42, v102
  v_sub_f32 v98, v42, v45
  v_sub_f32 v100, v102, v45
  v_exp_f32 v98, v98
  v_exp_f32 v100, v100
  v_mov_b32 v42, v45
  v_mul_f32 v43, v43, v98
  v_fma_f32 v43, v103, v100, v43
  v_pk_mul_f32 v[128:129], v[128:129], v[98:99] op_sel_hi:[1,0]
  v_pk_mul_f32 v[130:131], v[130:131], v[98:99] op_sel_hi:[1,0]
  v_pk_mul_f32 v[132:133], v[132:133], v[98:99] op_sel_hi:[1,0]
  v_pk_mul_f32 v[134:135], v[134:135], v[98:99] op_sel_hi:[1,0]
  v_pk_mul_f32 v[136:137], v[136:137], v[98:99] op_sel_hi:[1,0]
  v_pk_mul_f32 v[138:139], v[138:139], v[98:99] op_sel_hi:[1,0]
  v_pk_mul_f32 v[140:141], v[140:141], v[98:99] op_sel_hi:[1,0]
  v_pk_mul_f32 v[142:143], v[142:143], v[98:99] op_sel_hi:[1,0]
  v_pk_mul_f32 v[144:145], v[144:145], v[98:99] op_sel_hi:[1,0]
  v_pk_mul_f32 v[146:147], v[146:147], v[98:99] op_sel_hi:[1,0]
  v_pk_mul_f32 v[148:149], v[148:149], v[98:99] op_sel_hi:[1,0]
  v_pk_mul_f32 v[150:151], v[150:151], v[98:99] op_sel_hi:[1,0]
  v_pk_mul_f32 v[152:153], v[152:153], v[98:99] op_sel_hi:[1,0]
  v_pk_mul_f32 v[154:155], v[154:155], v[98:99] op_sel_hi:[1,0]
  v_pk_mul_f32 v[156:157], v[156:157], v[98:99] op_sel_hi:[1,0]
  v_pk_mul_f32 v[158:159], v[158:159], v[98:99] op_sel_hi:[1,0]
  s_waitcnt lgkmcnt(0)
  v_pk_fma_f32 v[128:129], v[160:161], v[100:101], v[128:129] op_sel_hi:[1,0,1]
  v_pk_fma_f32 v[130:131], v[162:163], v[100:101], v[130:131] op_sel_hi:[1,0,1]
  v_pk_fma_f32 v[132:133], v[164:165], v[100:101], v[132:133] op_sel_hi:[1,0,1]
  v_pk_fma_f32 v[134:135], v[166:167], v[100:101], v[134:135] op_sel_hi:[1,0,1]
  v_pk_fma_f32 v[136:137], v[168:169], v[100:101], v[136:137] op_sel_hi:[1,0,1]
  v_pk_fma_f32 v[138:139], v[170:171], v[100:101], v[138:139] op_sel_hi:[1,0,1]
  v_pk_fma_f32 v[140:141], v[172:173], v[100:101], v[140:141] op_sel_hi:[1,0,1]
  v_pk_fma_f32 v[142:143], v[174:175], v[100:101], v[142:143] op_sel_hi:[1,0,1]
  v_pk_fma_f32 v[144:145], v[176:177], v[100:101], v[144:145] op_sel_hi:[1,0,1]
  v_pk_fma_f32 v[146:147], v[178:179], v[100:101], v[146:147] op_sel_hi:[1,0,1]
  v_pk_fma_f32 v[148:149], v[180:181], v[100:101], v[148:149] op_sel_hi:[1,0,1]
  v_pk_fma_f32 v[150:151], v[182:183], v[100:101], v[150:151] op_sel_hi:[1,0,1]
  v_pk_fma_f32 v[152:153], v[184:185], v[100:101], v[152:153] op_sel_hi:[1,0,1]
  v_pk_fma_f32 v[154:155], v[186:187], v[100:101], v[154:155] op_sel_hi:[1,0,1]
  v_pk_fma_f32 v[156:157], v[188:189], v[100:101], v[156:157] op_sel_hi:[1,0,1]
  v_pk_fma_f32 v[158:159], v[190:191], v[100:101], v[158:159] op_sel_hi:[1,0,1]
L_nomerge_l3:
  s_waitcnt vmcnt(0)
  s_mov_b64 exec, 1
  ds_write_b32 v92, v93 offset:8
  s_mov_b64 exec, -1
  s_branch L_slice
L_consumer:
  s_cmp_eq_u32 s3, 2
  s_cselect_b32 s52, 1, 0
  s_cmp_eq_u32 s23, 0
  s_cselect_b32 s52, s52, 0
  s_cmp_eq_u32 s3, 2
  s_cbranch_scc1 L_not_q
  s_lshl_b32 s53, s22, 14
  s_lshl_b32 s54, s3, 13
  s_add_u32 s53, s53, s54
  s_add_u32 s36, s4, s53
  s_addc_u32 s37, s5, 0
  s_mov_b32 s38, 8192
  s_mov_b32 s39, 0x20000
  s_add_u32 m0, s54, 131072
  s_nop 0
  buffer_load_dwordx4 v10, s[36:39], 0 offen offset:0 nt lds
  buffer_load_dwordx4 v11, s[36:39], 0 offen offset:1024 nt lds
  buffer_load_dwordx4 v12, s[36:39], 0 offen offset:2048 nt lds
  buffer_load_dwordx4 v13, s[36:39], 0 offen offset:3072 nt lds
  s_add_u32 m0, s54, 135168
  s_nop 0
  buffer_load_dwordx4 v14, s[36:39], s40 offen offset:0 nt lds
  buffer_load_dwordx4 v15, s[36:39], s40 offen offset:1024 nt lds
  buffer_load_dwordx4 v16, s[36:39], s40 offen offset:2048 nt lds
  buffer_load_dwordx4 v17, s[36:39], s40 offen offset:3072 nt lds
  s_branch L_loads_done
L_not_q:
  s_cmp_eq_u32 s52, 0
  s_cbranch_scc1 L_loads_done
  s_lshl_b32 s53, s22, 13
  s_add_u32 s32, s10, s53
  s_addc_u32 s33, s11, 0
  s_mov_b32 s34, 8192
  s_mov_b32 s35, 0x20000
  s_mov_b32 m0, 147456
  s_nop 0
  buffer_load_dwordx4 v10, s[32:35], 0 offen offset:0 nt lds
  buffer_load_dwordx4 v11, s[32:35], 0 offen offset:1024 nt lds
  buffer_load_dwordx4 v12, s[32:35], 0 offen offset:2048 nt lds
  buffer_load_dwordx4 v13, s[32:35], 0 offen offset:3072 nt lds
  s_mov_b32 m0, 151552
  s_nop 0
  buffer_load_dwordx4 v14, s[32:35], s40 offen offset:0 nt lds
  buffer_load_dwordx4 v15, s[32:35], s40 offen offset:1024 nt lds
  buffer_load_dwordx4 v16, s[32:35], s40 offen offset:2048 nt lds
  buffer_load_dwordx4 v17, s[32:35], s40 offen offset:3072 nt lds
  s_add_u32 s32, s12, s53
  s_addc_u32 s33, s13, 0
  s_mov_b32 s34, 8192
  s_mov_b32 s35, 0x20000
  s_mov_b32 m0, 155648
  s_nop 0
  buffer_load_dwordx4 v10, s[32:35], 0 offen offset:0 nt lds
  buffer_load_dwordx4 v11, s[32:35], 0 offen offset:1024 nt lds
  buffer_load_dwordx4 v12, s[32:35], 0 offen offset:2048 nt lds
  buffer_load_dwordx4 v13, s[32:35], 0 offen offset:3072 nt lds
  s_mov_b32 m0, 159744
  s_nop 0
  buffer_load_dwordx4 v14, s[32:35], s40 offen offset:0 nt lds
  buffer_load_dwordx4 v15, s[32:35], s40 offen offset:1024 nt lds
  buffer_load_dwordx4 v16, s[32:35], s40 offen offset:2048 nt lds
  buffer_load_dwordx4 v17, s[32:35], s40 offen offset:3072 nt lds
  s_lshr_b32 s53, s22, 3
  s_lshl_b32 s53, s53, 9
  s_add_u32 s32, s14, s53
  s_addc_u32 s33, s15, 0
  s_mov_b32 s34, 512
  s_mov_b32 s35, 0x20000
  v_and_b32 v2, 15, v1
  v_lshlrev_b32 v2, 5, v2
  v_lshrrev_b32 v3, 5, v1
  v_lshl_add_u32 v2, v3, 3, v2
  buffer_load_dwordx2 v[72:73], v2, s[32:35], 0 offen
  buffer_load_dwordx2 v[74:75], v2, s[32:35], 0 offen offset:16
L_loads_done:
  s_sub_u32 s53, s49, s3
  s_add_u32 s53, s53, 2
  s_mul_hi_u32 s53, s53, 0x55555556
  s_cmp_eq_u32 s3, s78
  s_cselect_b32 s54, 1, 0
  s_sub_u32 s49, s53, s54
  v_and_b32 v3, 3, v1
  v_lshlrev_b32 v3, 2, v3
  v_bfe_u32 v4, v1, 2, 2
  v_or_b32 v3, v3, v4
  v_lshrrev_b32 v4, 5, v1
  v_xor_b32 v3, v3, v4
  v_lshlrev_b32 v3, 4, v3
  v_and_b32 v2, 31, v1
  v_lshl_add_u32 v3, v2, 9, v3
  v_add_u32 v18, s43, v3
  v_xor_b32 v19, 32, v18
  v_xor_b32 v20, 64, v18
  v_xor_b32 v21, 96, v18
  v_xor_b32 v22, 128, v18
  v_xor_b32 v23, 160, v18
  v_xor_b32 v24, 192, v18
  v_xor_b32 v25, 224, v18
  v_bfe_u32 v2, v1, 4, 1
  v_bfe_u32 v3, v1, 1, 1
  v_lshl_or_b32 v2, v2, 1, v3
  v_bfe_u32 v3, v1, 2, 2
  v_lshl_or_b32 v5, v3, 2, v4
  v_xor_b32 v2, v2, v5
  v_lshlrev_b32 v2, 4, v2
  v_lshl_add_u32 v3, v4, 2, v3
  v_lshl_add_u32 v2, v3, 9, v2
  v_and_b32 v3, 1, v1
  v_lshl_add_u32 v2, v3, 3, v2
  s_lshl_b32 s53, s3, 7
  v_xor_b32 v2, s53, v2
  v_add_u32 v26, s43, v2
  v_xor_b32 v27, 32, v26
  v_xor_b32 v28, 64, v26
  v_xor_b32 v29, 96, v26
  v_xor_b32 v30, 128, v26
  v_xor_b32 v31, 160, v26
  v_xor_b32 v32, 192, v26
  v_xor_b32 v33, 224, v26
  v_xor_b32 v34, 256, v26
  v_xor_b32 v35, 288, v26
  v_xor_b32 v36, 320, v26
  v_xor_b32 v37, 352, v26
  v_xor_b32 v38, 384, v26
  v_xor_b32 v39, 416, v26
  v_xor_b32 v40, 448, v26
  v_xor_b32 v41, 480, v26
  v_mov_b32 v42, 0xff800000
  v_mov_b32 v43, 0
  v_mov_b32 v128, 0
  v_mov_b32 v129, 0
  v_mov_b32 v130, 0
  v_mov_b32 v131, 0
  v_mov_b32 v132, 0
  v_mov_b32 v133, 0
  v_mov_b32 v134, 0
  v_mov_b32 v135, 0
  v_mov_b32 v136, 0
  v_mov_b32 v137, 0
  v_mov_b32 v138, 0
  v_mov_b32 v139, 0
  v_mov_b32 v140, 0
  v_mov_b32 v141, 0
  v_mov_b32 v142, 0
  v_mov_b32 v143, 0
  v_mov_b32 v144, 0
  v_mov_b32 v145, 0
  v_mov_b32 v146, 0
  v_mov_b32 v147, 0
  v_mov_b32 v148, 0
  v_mov_b32 v149, 0
  v_mov_b32 v150, 0
  v_mov_b32 v151, 0
  v_mov_b32 v152, 0
  v_mov_b32 v153, 0
  v_mov_b32 v154, 0
  v_mov_b32 v155, 0
  v_mov_b32 v156, 0
  v_mov_b32 v157, 0
  v_mov_b32 v158, 0
  v_mov_b32 v159, 0
  v_mov_b32 v160, 0
  v_mov_b32 v161, 0
  v_mov_b32 v162, 0
  v_mov_b32 v163, 0
  v_mov_b32 v164, 0
  v_mov_b32 v165, 0
  v_mov_b32 v166, 0
  v_mov_b32 v167, 0
  v_mov_b32 v168, 0
  v_mov_b32 v169, 0
  v_mov_b32 v170, 0
  v_mov_b32 v171, 0
  v_mov_b32 v172, 0
  v_mov_b32 v173, 0
  v_mov_b32 v174, 0
  v_mov_b32 v175, 0
  v_mov_b32 v176, 0
  v_mov_b32 v177, 0
  v_mov_b32 v178, 0
  v_mov_b32 v179, 0
  v_mov_b32 v180, 0
  v_mov_b32 v181, 0
  v_mov_b32 v182, 0
  v_mov_b32 v183, 0
  v_mov_b32 v184, 0
  v_mov_b32 v185, 0
  v_mov_b32 v186, 0
  v_mov_b32 v187, 0
  v_mov_b32 v188, 0
  v_mov_b32 v189, 0
  v_mov_b32 v190, 0
  v_mov_b32 v191, 0
  v_mov_b32 v192, 0
  v_mov_b32 v193, 0
  v_mov_b32 v194, 0
  v_mov_b32 v195, 0
  v_mov_b32 v196, 0
  v_mov_b32 v197, 0
  v_mov_b32 v198, 0
  v_mov_b32 v199, 0
  v_mov_b32 v200, 0
  v_mov_b32 v201, 0
  v_mov_b32 v202, 0
  v_mov_b32 v203, 0
  v_mov_b32 v204, 0
  v_mov_b32 v205, 0
  v_mov_b32 v206, 0
  v_mov_b32 v207, 0
  v_mov_b32 v208, 0
  v_mov_b32 v209, 0
  v_mov_b32 v210, 0
  v_mov_b32 v211, 0
  v_mov_b32 v212, 0
  v_mov_b32 v213, 0
  v_mov_b32 v214, 0
  v_mov_b32 v215, 0
  v_mov_b32 v216, 0
  v_mov_b32 v217, 0
  v_mov_b32 v218, 0
  v_mov_b32 v219, 0
  v_mov_b32 v220, 0
  v_mov_b32 v221, 0
  v_mov_b32 v222, 0
  v_mov_b32 v223, 0
  v_mov_b32 v224, 0
  v_mov_b32 v225, 0
  v_mov_b32 v226, 0
  v_mov_b32 v227, 0
  v_mov_b32 v228, 0
  v_mov_b32 v229, 0
  v_mov_b32 v230, 0
  v_mov_b32 v231, 0
  v_mov_b32 v232, 0
  v_mov_b32 v233, 0
  v_mov_b32 v234, 0
  v_mov_b32 v235, 0
  v_mov_b32 v236, 0
  v_mov_b32 v237, 0
  v_mov_b32 v238, 0
  v_mov_b32 v239, 0
  v_mov_b32 v240, 0
  v_mov_b32 v241, 0
  v_mov_b32 v242, 0
  v_mov_b32 v243, 0
  v_mov_b32 v244, 0
  v_mov_b32 v245, 0
  v_mov_b32 v246, 0
  v_mov_b32 v247, 0
  v_mov_b32 v248, 0
  v_mov_b32 v249, 0
  v_mov_b32 v250, 0
  v_mov_b32 v251, 0
  v_mov_b32 v252, 0
  v_mov_b32 v253, 0
  v_mov_b32 v254, 0
  v_mov_b32 v255, 0
  s_mov_b32 s50, 0x3db8aa3b
  s_mov_b32 s51, 0xceabfb8f
  s_lshl_b32 s53, s3, 4
  s_add_u32 s54, s53, 98304
  v_mov_b32 v92, s54
  s_add_u32 s54, s53, 98368
  v_mov_b32 v94, s54
  v_lshlrev_b32 v104, 3, v1
  v_lshlrev_b32 v105, 4, v1
  s_cmp_eq_u32 s3, s78
  s_cselect_b32 s53, 98304, s43
  v_add_u32 v106, s53, v105
  s_lshl_b32 s53, s3, 9
  s_add_u32 s53, s53, 100352
  v_add_u32 v107, s53, v104
  v_mov_b32 v109, 98448
  v_add_u32 v110, 102400, v105
  v_add_u32 v111, 101888, v104
  v_lshrrev_b32 v4, 5, v1
  v_bfe_u32 v2, v1, 4, 1
  v_bfe_u32 v3, v1, 1, 1
  v_lshl_or_b32 v2, v2, 1, v3
  v_bfe_u32 v3, v1, 2, 2
  v_lshl_or_b32 v5, v3, 2, v4
  v_xor_b32 v2, v2, v5
  v_lshlrev_b32 v2, 4, v2
  v_lshl_add_u32 v3, v4, 2, v3
  v_lshl_add_u32 v2, v3, 9, v2
  v_and_b32 v3, 1, v1
  v_lshl_add_u32 v2, v3, 3, v2
  s_lshl_b32 s53, s3, 7
  v_xor_b32 v2, s53, v2
  s_lshl_b32 s53, s78, 15
  s_add_u32 s53, s53, 16384
  v_add_u32 v112, s53, v2
  v_xor_b32 v113, 32, v112
  v_xor_b32 v114, 64, v112
  v_xor_b32 v115, 96, v112
  s_xor_b32 s54, s23, 0
  s_lshl_b32 s53, s22, 1
  s_add_u32 s54, s53, s54
  s_lshl_b32 s54, s54, 2
  s_add_u32 s54, s54, s3
  s_mul_i32 s54, s54, 8704
  s_add_u32 s32, s20, s54
  s_addc_u32 s33, s21, 0
  s_mov_b32 s34, 8704
  s_mov_b32 s35, 0x20000
  s_xor_b32 s54, s23, 1
  s_lshl_b32 s53, s22, 1
  s_add_u32 s54, s53, s54
  s_lshl_b32 s54, s54, 2
  s_add_u32 s54, s54, s3
  s_mul_i32 s54, s54, 8704
  s_add_u32 s36, s20, s54
  s_addc_u32 s37, s21, 0
  s_mov_b32 s38, 8704
  s_mov_b32 s39, 0x20000
  s_lshl_b32 s53, s22, 14
  s_add_u32 s92, s16, s53
  s_addc_u32 s93, s17, 0
  s_mov_b32 s94, 16384
  s_mov_b32 s95, 0x20000
  v_and_b32 v108, 31, v1
  v_lshlrev_b32 v108, 9, v108
  v_lshrrev_b32 v2, 5, v1
  v_lshl_add_u32 v108, v2, 4, v108
  s_lshl_b32 s53, s3, 7
  v_add_u32 v108, s53, v108
  s_sub_u32 s53, 131072, s43
  v_add_u32 v76, s53, v18
  v_add_u32 v77, s53, v19
  v_add_u32 v78, s53, v20
  v_add_u32 v79, s53, v21
  v_add_u32 v80, s53, v22
  v_add_u32 v81, s53, v23
  v_add_u32 v82, s53, v24
  v_add_u32 v83, s53, v25
  v_mov_b32 v96, 98432
  s_cmp_eq_u32 s3, 2
  s_cbranch_scc1 L_q_poll
  s_lshl_b32 s53, s3, 3
  v_add_u32 v97, s53, v96
  v_mov_b32 v93, 1
  s_waitcnt vmcnt(0)
  ds_write_b32 v97, v93
L_q_poll:
  ds_read2_b32 v[2:3], v96 offset0:0 offset1:2
  s_waitcnt lgkmcnt(0)
  v_and_b32 v2, v2, v3
  s_nop 0
  v_readfirstlane_b32 s53, v2
  s_nop 0
  s_cmp_eq_u32 s53, 0
  s_cbranch_scc1 L_q_poll
  ds_read_b128 a[0:3], v76 offset:0
  ds_read_b128 a[4:7], v77 offset:0
  ds_read_b128 a[8:11], v78 offset:0
  ds_read_b128 a[12:15], v79 offset:0
  ds_read_b128 a[16:19], v80 offset:0
  ds_read_b128 a[20:23], v81 offset:0
  ds_read_b128 a[24:27], v82 offset:0
  ds_read_b128 a[28:31], v83 offset:0
  ds_read_b128 a[32:35], v76 offset:256
  ds_read_b128 a[36:39], v77 offset:256
  ds_read_b128 a[40:43], v78 offset:256
  ds_read_b128 a[44:47], v79 offset:256
  ds_read_b128 a[48:51], v80 offset:256
  ds_read_b128 a[52:55], v81 offset:256
  ds_read_b128 a[56:59], v82 offset:256
  ds_read_b128 a[60:63], v83 offset:256
  s_waitcnt lgkmcnt(0)
  s_cmp_eq_u32 s52, 0
  s_cbranch_scc1 L_no_tree
  s_sub_u32 s53, 147456, s43
  v_add_u32 v76, s53, v18
  v_add_u32 v77, s53, v19
  v_add_u32 v78, s53, v20
  v_add_u32 v79, s53, v21
  v_add_u32 v80, s53, v22
  v_add_u32 v81, s53, v23
  v_add_u32 v82, s53, v24
  v_add_u32 v83, s53, v25
  s_waitcnt vmcnt(0)
  ds_read_b128 a[64:67], v76 offset:0
  ds_read_b128 a[68:71], v77 offset:0
  ds_read_b128 a[72:75], v78 offset:0
  ds_read_b128 a[76:79], v79 offset:0
  ds_read_b128 a[80:83], v80 offset:0
  ds_read_b128 a[84:87], v81 offset:0
  ds_read_b128 a[88:91], v82 offset:0
  ds_read_b128 a[92:95], v83 offset:0
  ds_read_b128 a[96:99], v76 offset:256
  ds_read_b128 a[100:103], v77 offset:256
  ds_read_b128 a[104:107], v78 offset:256
  ds_read_b128 a[108:111], v79 offset:256
  s_waitcnt lgkmcnt(11)
  v_mfma_f32_32x32x16_bf16 v[48:63], a[64:67], a[0:3], 0
  ds_read_b128 a[112:115], v80 offset:256
  s_waitcnt lgkmcnt(11)
  v_mfma_f32_32x32x16_bf16 v[48:63], a[68:71], a[4:7], v[48:63]
  ds_read_b128 a[116:119], v81 offset:256
  s_waitcnt lgkmcnt(11)
  v_mfma_f32_32x32x16_bf16 v[48:63], a[72:75], a[8:11], v[48:63]
  ds_read_b128 a[120:123], v82 offset:256
  s_waitcnt lgkmcnt(11)
  v_mfma_f32_32x32x16_bf16 v[48:63], a[76:79], a[12:15], v[48:63]
  ds_read_b128 a[124:127], v83 offset:256
  s_waitcnt lgkmcnt(11)
  v_mfma_f32_32x32x16_bf16 v[48:63], a[80:83], a[16:19], v[48:63]
  s_waitcnt lgkmcnt(10)
  v_mfma_f32_32x32x16_bf16 v[48:63], a[84:87], a[20:23], v[48:63]
  s_waitcnt lgkmcnt(9)
  v_mfma_f32_32x32x16_bf16 v[48:63], a[88:91], a[24:27], v[48:63]
  s_waitcnt lgkmcnt(8)
  v_mfma_f32_32x32x16_bf16 v[48:63], a[92:95], a[28:31], v[48:63]
  s_waitcnt lgkmcnt(7)
  v_mfma_f32_32x32x16_bf16 v[48:63], a[96:99], a[32:35], v[48:63]
  s_waitcnt lgkmcnt(6)
  v_mfma_f32_32x32x16_bf16 v[48:63], a[100:103], a[36:39], v[48:63]
  s_waitcnt lgkmcnt(5)
  v_mfma_f32_32x32x16_bf16 v[48:63], a[104:107], a[40:43], v[48:63]
  s_waitcnt lgkmcnt(4)
  v_mfma_f32_32x32x16_bf16 v[48:63], a[108:111], a[44:47], v[48:63]
  s_waitcnt lgkmcnt(3)
  v_mfma_f32_32x32x16_bf16 v[48:63], a[112:115], a[48:51], v[48:63]
  s_waitcnt lgkmcnt(2)
  v_mfma_f32_32x32x16_bf16 v[48:63], a[116:119], a[52:55], v[48:63]
  s_waitcnt lgkmcnt(1)
  v_mfma_f32_32x32x16_bf16 v[48:63], a[120:123], a[56:59], v[48:63]
  s_waitcnt lgkmcnt(0)
  v_mfma_f32_32x32x16_bf16 v[48:63], a[124:127], a[60:63], v[48:63]
  s_sub_u32 s53, 155648, s43
  v_add_u32 v76, s53, v26
  v_add_u32 v77, s53, v27
  v_add_u32 v78, s53, v28
  v_add_u32 v79, s53, v29
  v_add_u32 v80, s53, v30
  v_add_u32 v81, s53, v31
  v_add_u32 v82, s53, v32
  v_add_u32 v83, s53, v33
  v_add_u32 v84, s53, v34
  v_add_u32 v85, s53, v35
  v_add_u32 v86, s53, v36
  v_add_u32 v87, s53, v37
  v_add_u32 v88, s53, v38
  v_add_u32 v89, s53, v39
  v_add_u32 v90, s53, v40
  v_add_u32 v91, s53, v41
  v_lshlrev_b32 v2, 16, v72
  v_sub_f32 v2, 1.0, v2
  v_mul_f32 v64, s51, v2
  v_and_b32 v2, 0xffff0000, v72
  v_sub_f32 v2, 1.0, v2
  v_mul_f32 v65, s51, v2
  v_lshlrev_b32 v2, 16, v73
  v_sub_f32 v2, 1.0, v2
  v_mul_f32 v66, s51, v2
  v_and_b32 v2, 0xffff0000, v73
  v_sub_f32 v2, 1.0, v2
  v_mul_f32 v67, s51, v2
  v_lshlrev_b32 v2, 16, v74
  v_sub_f32 v2, 1.0, v2
  v_mul_f32 v68, s51, v2
  v_and_b32 v2, 0xffff0000, v74
  v_sub_f32 v2, 1.0, v2
  v_mul_f32 v69, s51, v2
  v_lshlrev_b32 v2, 16, v75
  v_sub_f32 v2, 1.0, v2
  v_mul_f32 v70, s51, v2
  v_and_b32 v2, 0xffff0000, v75
  v_sub_f32 v2, 1.0, v2
  v_mul_f32 v71, s51, v2
  v_fma_f32 v48, v48, s50, v64
  v_fma_f32 v49, v49, s50, v65
  v_fma_f32 v50, v50, s50, v66
  v_fma_f32 v51, v51, s50, v67
  v_fma_f32 v52, v52, s50, v68
  v_fma_f32 v53, v53, s50, v69
  v_fma_f32 v54, v54, s50, v70
  v_fma_f32 v55, v55, s50, v71
  v_max3_f32 v46, v48, v49, v50
  v_max3_f32 v46, v46, v51, v52
  v_max3_f32 v46, v46, v53, v54
  v_max_f32 v46, v46, v55
  v_mov_b32 v47, v46
  s_nop 1
  v_permlane32_swap_b32 v46, v47
  v_max_f32 v46, v46, v47
  v_cmp_gt_f32 vcc, v46, v42
  s_cmp_eq_u64 vcc, 0
  s_cbranch_scc1 L_keep_t
  v_max_f32 v45, v42, v46
  v_sub_f32 v44, v42, v45
  v_exp_f32 v44, v44
  v_mov_b32 v42, v45
  v_mul_f32 v43, v43, v44
  v_pk_mul_f32 v[128:129], v[128:129], v[44:45] op_sel_hi:[1,0]
  v_pk_mul_f32 v[130:131], v[130:131], v[44:45] op_sel_hi:[1,0]
  v_pk_mul_f32 v[132:133], v[132:133], v[44:45] op_sel_hi:[1,0]
  v_pk_mul_f32 v[134:135], v[134:135], v[44:45] op_sel_hi:[1,0]
  v_pk_mul_f32 v[136:137], v[136:137], v[44:45] op_sel_hi:[1,0]
  v_pk_mul_f32 v[138:139], v[138:139], v[44:45] op_sel_hi:[1,0]
  v_pk_mul_f32 v[140:141], v[140:141], v[44:45] op_sel_hi:[1,0]
  v_pk_mul_f32 v[142:143], v[142:143], v[44:45] op_sel_hi:[1,0]
  v_pk_mul_f32 v[144:145], v[144:145], v[44:45] op_sel_hi:[1,0]
  v_pk_mul_f32 v[146:147], v[146:147], v[44:45] op_sel_hi:[1,0]
  v_pk_mul_f32 v[148:149], v[148:149], v[44:45] op_sel_hi:[1,0]
  v_pk_mul_f32 v[150:151], v[150:151], v[44:45] op_sel_hi:[1,0]
  v_pk_mul_f32 v[152:153], v[152:153], v[44:45] op_sel_hi:[1,0]
  v_pk_mul_f32 v[154:155], v[154:155], v[44:45] op_sel_hi:[1,0]
  v_pk_mul_f32 v[156:157], v[156:157], v[44:45] op_sel_hi:[1,0]
  v_pk_mul_f32 v[158:159], v[158:159], v[44:45] op_sel_hi:[1,0]
  v_pk_mul_f32 v[160:161], v[160:161], v[44:45] op_sel_hi:[1,0]
  v_pk_mul_f32 v[162:163], v[162:163], v[44:45] op_sel_hi:[1,0]
  v_pk_mul_f32 v[164:165], v[164:165], v[44:45] op_sel_hi:[1,0]
  v_pk_mul_f32 v[166:167], v[166:167], v[44:45] op_sel_hi:[1,0]
  v_pk_mul_f32 v[168:169], v[168:169], v[44:45] op_sel_hi:[1,0]
  v_pk_mul_f32 v[170:171], v[170:171], v[44:45] op_sel_hi:[1,0]
  v_pk_mul_f32 v[172:173], v[172:173], v[44:45] op_sel_hi:[1,0]
  v_pk_mul_f32 v[174:175], v[174:175], v[44:45] op_sel_hi:[1,0]
  v_pk_mul_f32 v[176:177], v[176:177], v[44:45] op_sel_hi:[1,0]
  v_pk_mul_f32 v[178:179], v[178:179], v[44:45] op_sel_hi:[1,0]
  v_pk_mul_f32 v[180:181], v[180:181], v[44:45] op_sel_hi:[1,0]
  v_pk_mul_f32 v[182:183], v[182:183], v[44:45] op_sel_hi:[1,0]
  v_pk_mul_f32 v[184:185], v[184:185], v[44:45] op_sel_hi:[1,0]
  v_pk_mul_f32 v[186:187], v[186:187], v[44:45] op_sel_hi:[1,0]
  v_pk_mul_f32 v[188:189], v[188:189], v[44:45] op_sel_hi:[1,0]
  v_pk_mul_f32 v[190:191], v[190:191], v[44:45] op_sel_hi:[1,0]
  v_pk_mul_f32 v[192:193], v[192:193], v[44:45] op_sel_hi:[1,0]
  v_pk_mul_f32 v[194:195], v[194:195], v[44:45] op_sel_hi:[1,0]
  v_pk_mul_f32 v[196:197], v[196:197], v[44:45] op_sel_hi:[1,0]
  v_pk_mul_f32 v[198:199], v[198:199], v[44:45] op_sel_hi:[1,0]
  v_pk_mul_f32 v[200:201], v[200:201], v[44:45] op_sel_hi:[1,0]
  v_pk_mul_f32 v[202:203], v[202:203], v[44:45] op_sel_hi:[1,0]
  v_pk_mul_f32 v[204:205], v[204:205], v[44:45] op_sel_hi:[1,0]
  v_pk_mul_f32 v[206:207], v[206:207], v[44:45] op_sel_hi:[1,0]
  v_pk_mul_f32 v[208:209], v[208:209], v[44:45] op_sel_hi:[1,0]
  v_pk_mul_f32 v[210:211], v[210:211], v[44:45] op_sel_hi:[1,0]
  v_pk_mul_f32 v[212:213], v[212:213], v[44:45] op_sel_hi:[1,0]
  v_pk_mul_f32 v[214:215], v[214:215], v[44:45] op_sel_hi:[1,0]
  v_pk_mul_f32 v[216:217], v[216:217], v[44:45] op_sel_hi:[1,0]
  v_pk_mul_f32 v[218:219], v[218:219], v[44:45] op_sel_hi:[1,0]
  v_pk_mul_f32 v[220:221], v[220:221], v[44:45] op_sel_hi:[1,0]
  v_pk_mul_f32 v[222:223], v[222:223], v[44:45] op_sel_hi:[1,0]
  v_pk_mul_f32 v[224:225], v[224:225], v[44:45] op_sel_hi:[1,0]
  v_pk_mul_f32 v[226:227], v[226:227], v[44:45] op_sel_hi:[1,0]
  v_pk_mul_f32 v[228:229], v[228:229], v[44:45] op_sel_hi:[1,0]
  v_pk_mul_f32 v[230:231], v[230:231], v[44:45] op_sel_hi:[1,0]
  v_pk_mul_f32 v[232:233], v[232:233], v[44:45] op_sel_hi:[1,0]
  v_pk_mul_f32 v[234:235], v[234:235], v[44:45] op_sel_hi:[1,0]
  v_pk_mul_f32 v[236:237], v[236:237], v[44:45] op_sel_hi:[1,0]
  v_pk_mul_f32 v[238:239], v[238:239], v[44:45] op_sel_hi:[1,0]
  v_pk_mul_f32 v[240:241], v[240:241], v[44:45] op_sel_hi:[1,0]
  v_pk_mul_f32 v[242:243], v[242:243], v[44:45] op_sel_hi:[1,0]
  v_pk_mul_f32 v[244:245], v[244:245], v[44:45] op_sel_hi:[1,0]
  v_pk_mul_f32 v[246:247], v[246:247], v[44:45] op_sel_hi:[1,0]
  v_pk_mul_f32 v[248:249], v[248:249], v[44:45] op_sel_hi:[1,0]
  v_pk_mul_f32 v[250:251], v[250:251], v[44:45] op_sel_hi:[1,0]
  v_pk_mul_f32 v[252:253], v[252:253], v[44:45] op_sel_hi:[1,0]
  v_pk_mul_f32 v[254:255], v[254:255], v[44:45] op_sel_hi:[1,0]
L_keep_t:
  v_sub_f32 v48, v48, v42
  v_sub_f32 v49, v49, v42
  v_sub_f32 v50, v50, v42
  v_sub_f32 v51, v51, v42
  v_sub_f32 v52, v52, v42
  v_sub_f32 v53, v53, v42
  v_sub_f32 v54, v54, v42
  v_sub_f32 v55, v55, v42
  v_exp_f32 v48, v48
  v_exp_f32 v49, v49
  v_exp_f32 v50, v50
  v_exp_f32 v51, v51
  v_exp_f32 v52, v52
  v_exp_f32 v53, v53
  v_exp_f32 v54, v54
  v_exp_f32 v55, v55
  s_nop 0
  v_add_f32 v46, v48, v49
  v_add_f32 v47, v50, v51
  v_add_f32 v46, v46, v52
  v_add_f32 v46, v46, v53
  v_add_f32 v47, v47, v54
  v_add_f32 v47, v47, v55
  v_cvt_pk_bf16_f32 v64, v48, v49
  v_cvt_pk_bf16_f32 v65, v50, v51
  v_cvt_pk_bf16_f32 v66, v52, v53
  v_cvt_pk_bf16_f32 v67, v54, v55
  v_add_f32 v46, v46, v47
  v_add_f32 v43, v43, v46
  s_nop 1
  ds_read_b64_tr_b16 a[128:129], v76 offset:0
  ds_read_b64_tr_b16 a[130:131], v77 offset:4096
  ds_read_b64_tr_b16 a[132:133], v78 offset:0
  ds_read_b64_tr_b16 a[134:135], v79 offset:4096
  ds_read_b64_tr_b16 a[136:137], v80 offset:0
  ds_read_b64_tr_b16 a[138:139], v81 offset:4096
  ds_read_b64_tr_b16 a[140:141], v82 offset:0
  ds_read_b64_tr_b16 a[142:143], v83 offset:4096
  ds_read_b64_tr_b16 a[144:145], v84 offset:0
  ds_read_b64_tr_b16 a[146:147], v85 offset:4096
  ds_read_b64_tr_b16 a[148:149], v86 offset:0
  ds_read_b64_tr_b16 a[150:151], v87 offset:4096
  ds_read_b64_tr_b16 a[152:153], v88 offset:0
  ds_read_b64_tr_b16 a[154:155], v89 offset:4096
  s_waitcnt lgkmcnt(12)
  v_mfma_f32_32x32x16_bf16 v[128:143], a[128:131], v[64:67], v[128:143]
  ds_read_b64_tr_b16 a[156:157], v90 offset:0
  ds_read_b64_tr_b16 a[158:159], v91 offset:4096
  s_waitcnt lgkmcnt(12)
  v_mfma_f32_32x32x16_bf16 v[144:159], a[132:135], v[64:67], v[144:159]
  s_waitcnt lgkmcnt(10)
  v_mfma_f32_32x32x16_bf16 v[160:175], a[136:139], v[64:67], v[160:175]
  s_waitcnt lgkmcnt(8)
  v_mfma_f32_32x32x16_bf16 v[176:191], a[140:143], v[64:67], v[176:191]
  s_waitcnt lgkmcnt(6)
  v_mfma_f32_32x32x16_bf16 v[192:207], a[144:147], v[64:67], v[192:207]
  s_waitcnt lgkmcnt(4)
  v_mfma_f32_32x32x16_bf16 v[208:223], a[148:151], v[64:67], v[208:223]
  s_waitcnt lgkmcnt(2)
  v_mfma_f32_32x32x16_bf16 v[224:239], a[152:155], v[64:67], v[224:239]
  s_waitcnt lgkmcnt(0)
  v_mfma_f32_32x32x16_bf16 v[240:255], a[156:159], v[64:67], v[240:255]
L_no_tree:
  s_mov_b32 s46, 0
L_loop:
  s_add_u32 s57, s46, 1
  v_mov_b32 v93, s57
L_w_k:
  ds_read_b32 v95, v92 offset:0
  s_waitcnt lgkmcnt(0)
  v_readfirstlane_b32 s53, v95
  s_nop 0
  s_cmp_gt_u32 s53, s46
  s_cbranch_scc1 L_g_k
  s_sleep 1
  s_branch L_w_k
L_g_k:
  ds_read_b128 a[64:67], v18 offset:0
  ds_read_b128 a[68:71], v19 offset:0
  ds_read_b128 a[72:75], v20 offset:0
  ds_read_b128 a[76:79], v21 offset:0
  ds_read_b128 a[80:83], v22 offset:0
  ds_read_b128 a[84:87], v23 offset:0
  ds_read_b128 a[88:91], v24 offset:0
  ds_read_b128 a[92:95], v25 offset:0
  ds_read_b128 a[96:99], v18 offset:256
  ds_read_b128 a[100:103], v19 offset:256
  ds_read_b128 a[104:107], v20 offset:256
  ds_read_b128 a[108:111], v21 offset:256
  s_waitcnt lgkmcnt(11)
  v_mfma_f32_32x32x16_bf16 v[48:63], a[64:67], a[0:3], 0
  ds_read_b128 a[112:115], v22 offset:256
  s_waitcnt lgkmcnt(11)
  v_mfma_f32_32x32x16_bf16 v[48:63], a[68:71], a[4:7], v[48:63]
  ds_read_b128 a[116:119], v23 offset:256
  s_waitcnt lgkmcnt(11)
  v_mfma_f32_32x32x16_bf16 v[48:63], a[72:75], a[8:11], v[48:63]
  ds_read_b128 a[120:123], v24 offset:256
  s_waitcnt lgkmcnt(11)
  v_mfma_f32_32x32x16_bf16 v[48:63], a[76:79], a[12:15], v[48:63]
  ds_read_b128 a[124:127], v25 offset:256
  s_waitcnt lgkmcnt(11)
  v_mfma_f32_32x32x16_bf16 v[48:63], a[80:83], a[16:19], v[48:63]
  s_waitcnt lgkmcnt(10)
  v_mfma_f32_32x32x16_bf16 v[48:63], a[84:87], a[20:23], v[48:63]
  s_waitcnt lgkmcnt(9)
  v_mfma_f32_32x32x16_bf16 v[48:63], a[88:91], a[24:27], v[48:63]
  s_waitcnt lgkmcnt(8)
  v_mfma_f32_32x32x16_bf16 v[48:63], a[92:95], a[28:31], v[48:63]
  s_waitcnt lgkmcnt(7)
  v_mfma_f32_32x32x16_bf16 v[48:63], a[96:99], a[32:35], v[48:63]
  s_waitcnt lgkmcnt(6)
  v_mfma_f32_32x32x16_bf16 v[48:63], a[100:103], a[36:39], v[48:63]
  s_waitcnt lgkmcnt(5)
  v_mfma_f32_32x32x16_bf16 v[48:63], a[104:107], a[40:43], v[48:63]
  s_waitcnt lgkmcnt(4)
  v_mfma_f32_32x32x16_bf16 v[48:63], a[108:111], a[44:47], v[48:63]
  s_waitcnt lgkmcnt(3)
  v_mfma_f32_32x32x16_bf16 v[48:63], a[112:115], a[48:51], v[48:63]
  s_waitcnt lgkmcnt(2)
  v_mfma_f32_32x32x16_bf16 v[48:63], a[116:119], a[52:55], v[48:63]
  s_waitcnt lgkmcnt(1)
  v_mfma_f32_32x32x16_bf16 v[48:63], a[120:123], a[56:59], v[48:63]
  s_waitcnt lgkmcnt(0)
  v_mfma_f32_32x32x16_bf16 v[48:63], a[124:127], a[60:63], v[48:63]
  s_mov_b64 exec, 1
  ds_write_b32 v94, v93 offset:0
  s_mov_b64 exec, -1
  s_nop 7
  s_nop 1
  v_max3_f32 v46, v48, v49, v50
  v_max3_f32 v46, v46, v51, v52
  v_max3_f32 v46, v46, v53, v54
  v_max3_f32 v46, v46, v55, v56
  v_max3_f32 v46, v46, v57, v58
  v_max3_f32 v46, v46, v59, v60
  v_max3_f32 v46, v46, v61, v62
  v_max_f32 v46, v46, v63
  v_mov_b32 v47, v46
  s_nop 1
  v_permlane32_swap_b32 v46, v47
  v_max_f32 v46, v46, v47
  v_mul_f32 v46, s50, v46
  v_cmp_gt_f32 vcc, v46, v42
  s_cmp_eq_u64 vcc, 0
  s_cbranch_scc1 L_keep_m
  v_max_f32 v45, v42, v46
  v_sub_f32 v44, v42, v45
  v_exp_f32 v44, v44
  v_mov_b32 v42, v45
  v_mul_f32 v43, v43, v44
  v_pk_mul_f32 v[128:129], v[128:129], v[44:45] op_sel_hi:[1,0]
  v_pk_mul_f32 v[130:131], v[130:131], v[44:45] op_sel_hi:[1,0]
  v_pk_mul_f32 v[132:133], v[132:133], v[44:45] op_sel_hi:[1,0]
  v_pk_mul_f32 v[134:135], v[134:135], v[44:45] op_sel_hi:[1,0]
  v_pk_mul_f32 v[136:137], v[136:137], v[44:45] op_sel_hi:[1,0]
  v_pk_mul_f32 v[138:139], v[138:139], v[44:45] op_sel_hi:[1,0]
  v_pk_mul_f32 v[140:141], v[140:141], v[44:45] op_sel_hi:[1,0]
  v_pk_mul_f32 v[142:143], v[142:143], v[44:45] op_sel_hi:[1,0]
  v_pk_mul_f32 v[144:145], v[144:145], v[44:45] op_sel_hi:[1,0]
  v_pk_mul_f32 v[146:147], v[146:147], v[44:45] op_sel_hi:[1,0]
  v_pk_mul_f32 v[148:149], v[148:149], v[44:45] op_sel_hi:[1,0]
  v_pk_mul_f32 v[150:151], v[150:151], v[44:45] op_sel_hi:[1,0]
  v_pk_mul_f32 v[152:153], v[152:153], v[44:45] op_sel_hi:[1,0]
  v_pk_mul_f32 v[154:155], v[154:155], v[44:45] op_sel_hi:[1,0]
  v_pk_mul_f32 v[156:157], v[156:157], v[44:45] op_sel_hi:[1,0]
  v_pk_mul_f32 v[158:159], v[158:159], v[44:45] op_sel_hi:[1,0]
  v_pk_mul_f32 v[160:161], v[160:161], v[44:45] op_sel_hi:[1,0]
  v_pk_mul_f32 v[162:163], v[162:163], v[44:45] op_sel_hi:[1,0]
  v_pk_mul_f32 v[164:165], v[164:165], v[44:45] op_sel_hi:[1,0]
  v_pk_mul_f32 v[166:167], v[166:167], v[44:45] op_sel_hi:[1,0]
  v_pk_mul_f32 v[168:169], v[168:169], v[44:45] op_sel_hi:[1,0]
  v_pk_mul_f32 v[170:171], v[170:171], v[44:45] op_sel_hi:[1,0]
  v_pk_mul_f32 v[172:173], v[172:173], v[44:45] op_sel_hi:[1,0]
  v_pk_mul_f32 v[174:175], v[174:175], v[44:45] op_sel_hi:[1,0]
  v_pk_mul_f32 v[176:177], v[176:177], v[44:45] op_sel_hi:[1,0]
  v_pk_mul_f32 v[178:179], v[178:179], v[44:45] op_sel_hi:[1,0]
  v_pk_mul_f32 v[180:181], v[180:181], v[44:45] op_sel_hi:[1,0]
  v_pk_mul_f32 v[182:183], v[182:183], v[44:45] op_sel_hi:[1,0]
  v_pk_mul_f32 v[184:185], v[184:185], v[44:45] op_sel_hi:[1,0]
  v_pk_mul_f32 v[186:187], v[186:187], v[44:45] op_sel_hi:[1,0]
  v_pk_mul_f32 v[188:189], v[188:189], v[44:45] op_sel_hi:[1,0]
  v_pk_mul_f32 v[190:191], v[190:191], v[44:45] op_sel_hi:[1,0]
  v_pk_mul_f32 v[192:193], v[192:193], v[44:45] op_sel_hi:[1,0]
  v_pk_mul_f32 v[194:195], v[194:195], v[44:45] op_sel_hi:[1,0]
  v_pk_mul_f32 v[196:197], v[196:197], v[44:45] op_sel_hi:[1,0]
  v_pk_mul_f32 v[198:199], v[198:199], v[44:45] op_sel_hi:[1,0]
  v_pk_mul_f32 v[200:201], v[200:201], v[44:45] op_sel_hi:[1,0]
  v_pk_mul_f32 v[202:203], v[202:203], v[44:45] op_sel_hi:[1,0]
  v_pk_mul_f32 v[204:205], v[204:205], v[44:45] op_sel_hi:[1,0]
  v_pk_mul_f32 v[206:207], v[206:207], v[44:45] op_sel_hi:[1,0]
  v_pk_mul_f32 v[208:209], v[208:209], v[44:45] op_sel_hi:[1,0]
  v_pk_mul_f32 v[210:211], v[210:211], v[44:45] op_sel_hi:[1,0]
  v_pk_mul_f32 v[212:213], v[212:213], v[44:45] op_sel_hi:[1,0]
  v_pk_mul_f32 v[214:215], v[214:215], v[44:45] op_sel_hi:[1,0]
  v_pk_mul_f32 v[216:217], v[216:217], v[44:45] op_sel_hi:[1,0]
  v_pk_mul_f32 v[218:219], v[218:219], v[44:45] op_sel_hi:[1,0]
  v_pk_mul_f32 v[220:221], v[220:221], v[44:45] op_sel_hi:[1,0]
  v_pk_mul_f32 v[222:223], v[222:223], v[44:45] op_sel_hi:[1,0]
  v_pk_mul_f32 v[224:225], v[224:225], v[44:45] op_sel_hi:[1,0]
  v_pk_mul_f32 v[226:227], v[226:227], v[44:45] op_sel_hi:[1,0]
  v_pk_mul_f32 v[228:229], v[228:229], v[44:45] op_sel_hi:[1,0]
  v_pk_mul_f32 v[230:231], v[230:231], v[44:45] op_sel_hi:[1,0]
  v_pk_mul_f32 v[232:233], v[232:233], v[44:45] op_sel_hi:[1,0]
  v_pk_mul_f32 v[234:235], v[234:235], v[44:45] op_sel_hi:[1,0]
  v_pk_mul_f32 v[236:237], v[236:237], v[44:45] op_sel_hi:[1,0]
  v_pk_mul_f32 v[238:239], v[238:239], v[44:45] op_sel_hi:[1,0]
  v_pk_mul_f32 v[240:241], v[240:241], v[44:45] op_sel_hi:[1,0]
  v_pk_mul_f32 v[242:243], v[242:243], v[44:45] op_sel_hi:[1,0]
  v_pk_mul_f32 v[244:245], v[244:245], v[44:45] op_sel_hi:[1,0]
  v_pk_mul_f32 v[246:247], v[246:247], v[44:45] op_sel_hi:[1,0]
  v_pk_mul_f32 v[248:249], v[248:249], v[44:45] op_sel_hi:[1,0]
  v_pk_mul_f32 v[250:251], v[250:251], v[44:45] op_sel_hi:[1,0]
  v_pk_mul_f32 v[252:253], v[252:253], v[44:45] op_sel_hi:[1,0]
  v_pk_mul_f32 v[254:255], v[254:255], v[44:45] op_sel_hi:[1,0]
L_keep_m:
  v_fma_f32 v48, v48, s50, -v42
  v_fma_f32 v49, v49, s50, -v42
  v_fma_f32 v50, v50, s50, -v42
  v_fma_f32 v51, v51, s50, -v42
  v_fma_f32 v52, v52, s50, -v42
  v_fma_f32 v53, v53, s50, -v42
  v_fma_f32 v54, v54, s50, -v42
  v_fma_f32 v55, v55, s50, -v42
  v_fma_f32 v56, v56, s50, -v42
  v_fma_f32 v57, v57, s50, -v42
  v_fma_f32 v58, v58, s50, -v42
  v_fma_f32 v59, v59, s50, -v42
  v_fma_f32 v60, v60, s50, -v42
  v_fma_f32 v61, v61, s50, -v42
  v_fma_f32 v62, v62, s50, -v42
  v_fma_f32 v63, v63, s50, -v42
  v_exp_f32 v48, v48
  v_exp_f32 v49, v49
  v_exp_f32 v50, v50
  v_exp_f32 v51, v51
  v_exp_f32 v52, v52
  v_exp_f32 v53, v53
  v_exp_f32 v54, v54
  v_exp_f32 v55, v55
  v_exp_f32 v56, v56
  v_exp_f32 v57, v57
  v_exp_f32 v58, v58
  v_exp_f32 v59, v59
  v_exp_f32 v60, v60
  v_exp_f32 v61, v61
  v_exp_f32 v62, v62
  v_exp_f32 v63, v63
  s_nop 0
  v_add_f32 v46, v48, v49
  v_add_f32 v47, v50, v51
  v_add_f32 v46, v46, v52
  v_add_f32 v46, v46, v53
  v_add_f32 v47, v47, v54
  v_add_f32 v47, v47, v55
  v_add_f32 v46, v46, v56
  v_add_f32 v46, v46, v57
  v_add_f32 v47, v47, v58
  v_add_f32 v47, v47, v59
  v_add_f32 v46, v46, v60
  v_add_f32 v46, v46, v61
  v_add_f32 v47, v47, v62
  v_add_f32 v47, v47, v63
  v_cvt_pk_bf16_f32 v64, v48, v49
  v_cvt_pk_bf16_f32 v65, v50, v51
  v_cvt_pk_bf16_f32 v66, v52, v53
  v_cvt_pk_bf16_f32 v67, v54, v55
  v_cvt_pk_bf16_f32 v68, v56, v57
  v_cvt_pk_bf16_f32 v69, v58, v59
  v_cvt_pk_bf16_f32 v70, v60, v61
  v_cvt_pk_bf16_f32 v71, v62, v63
  v_add_f32 v46, v46, v47
  v_add_f32 v43, v43, v46
L_w_v:
  ds_read_b32 v95, v92 offset:8
  s_waitcnt lgkmcnt(0)
  v_readfirstlane_b32 s53, v95
  s_nop 0
  s_cmp_gt_u32 s53, s46
  s_cbranch_scc1 L_g_v
  s_sleep 1
  s_branch L_w_v
L_g_v:
  ds_read_b64_tr_b16 a[128:129], v26 offset:16384
  ds_read_b64_tr_b16 a[130:131], v27 offset:20480
  ds_read_b64_tr_b16 a[132:133], v28 offset:16384
  ds_read_b64_tr_b16 a[134:135], v29 offset:20480
  ds_read_b64_tr_b16 a[136:137], v30 offset:16384
  ds_read_b64_tr_b16 a[138:139], v31 offset:20480
  ds_read_b64_tr_b16 a[140:141], v32 offset:16384
  ds_read_b64_tr_b16 a[142:143], v33 offset:20480
  ds_read_b64_tr_b16 a[144:145], v34 offset:16384
  ds_read_b64_tr_b16 a[146:147], v35 offset:20480
  ds_read_b64_tr_b16 a[148:149], v36 offset:16384
  ds_read_b64_tr_b16 a[150:151], v37 offset:20480
  ds_read_b64_tr_b16 a[152:153], v38 offset:16384
  ds_read_b64_tr_b16 a[154:155], v39 offset:20480
  s_waitcnt lgkmcnt(12)
  v_mfma_f32_32x32x16_bf16 v[128:143], a[128:131], v[64:67], v[128:143]
  ds_read_b64_tr_b16 a[156:157], v40 offset:16384
  ds_read_b64_tr_b16 a[158:159], v41 offset:20480
  s_waitcnt lgkmcnt(12)
  v_mfma_f32_32x32x16_bf16 v[144:159], a[132:135], v[64:67], v[144:159]
  ds_read_b64_tr_b16 a[160:161], v26 offset:24576
  ds_read_b64_tr_b16 a[162:163], v27 offset:28672
  s_waitcnt lgkmcnt(12)
  v_mfma_f32_32x32x16_bf16 v[160:175], a[136:139], v[64:67], v[160:175]
  ds_read_b64_tr_b16 a[164:165], v28 offset:24576
  ds_read_b64_tr_b16 a[166:167], v29 offset:28672
  s_waitcnt lgkmcnt(12)
  v_mfma_f32_32x32x16_bf16 v[176:191], a[140:143], v[64:67], v[176:191]
  ds_read_b64_tr_b16 a[168:169], v30 offset:24576
  ds_read_b64_tr_b16 a[170:171], v31 offset:28672
  s_waitcnt lgkmcnt(12)
  v_mfma_f32_32x32x16_bf16 v[192:207], a[144:147], v[64:67], v[192:207]
  ds_read_b64_tr_b16 a[172:173], v32 offset:24576
  ds_read_b64_tr_b16 a[174:175], v33 offset:28672
  s_waitcnt lgkmcnt(12)
  v_mfma_f32_32x32x16_bf16 v[208:223], a[148:151], v[64:67], v[208:223]
  ds_read_b64_tr_b16 a[176:177], v34 offset:24576
  ds_read_b64_tr_b16 a[178:179], v35 offset:28672
  s_waitcnt lgkmcnt(12)
  v_mfma_f32_32x32x16_bf16 v[224:239], a[152:155], v[64:67], v[224:239]
  ds_read_b64_tr_b16 a[180:181], v36 offset:24576
  ds_read_b64_tr_b16 a[182:183], v37 offset:28672
  s_waitcnt lgkmcnt(12)
  v_mfma_f32_32x32x16_bf16 v[240:255], a[156:159], v[64:67], v[240:255]
  ds_read_b64_tr_b16 a[184:185], v38 offset:24576
  ds_read_b64_tr_b16 a[186:187], v39 offset:28672
  s_waitcnt lgkmcnt(12)
  v_mfma_f32_32x32x16_bf16 v[128:143], a[160:163], v[68:71], v[128:143]
  ds_read_b64_tr_b16 a[188:189], v40 offset:24576
  ds_read_b64_tr_b16 a[190:191], v41 offset:28672
  s_waitcnt lgkmcnt(12)
  v_mfma_f32_32x32x16_bf16 v[144:159], a[164:167], v[68:71], v[144:159]
  s_waitcnt lgkmcnt(10)
  v_mfma_f32_32x32x16_bf16 v[160:175], a[168:171], v[68:71], v[160:175]
  s_waitcnt lgkmcnt(8)
  v_mfma_f32_32x32x16_bf16 v[176:191], a[172:175], v[68:71], v[176:191]
  s_waitcnt lgkmcnt(6)
  v_mfma_f32_32x32x16_bf16 v[192:207], a[176:179], v[68:71], v[192:207]
  s_waitcnt lgkmcnt(4)
  v_mfma_f32_32x32x16_bf16 v[208:223], a[180:183], v[68:71], v[208:223]
  s_waitcnt lgkmcnt(2)
  v_mfma_f32_32x32x16_bf16 v[224:239], a[184:187], v[68:71], v[224:239]
  s_waitcnt lgkmcnt(0)
  v_mfma_f32_32x32x16_bf16 v[240:255], a[188:191], v[68:71], v[240:255]
  s_mov_b64 exec, 1
  ds_write_b32 v94, v93 offset:8
  s_mov_b64 exec, -1
  s_mov_b32 s46, s57
  s_cmp_lt_u32 s46, s49
  s_cbranch_scc1 L_loop
  v_mov_b32 v46, v43
  s_nop 1
  v_permlane32_swap_b32 v46, v43
  v_add_f32 v43, v43, v46
  s_nop 3
  ds_write_b64 v107, v[42:43]
  ds_write_b128 v106, v[160:163] offset:8192
  ds_write_b128 v106, v[164:167] offset:9216
  ds_write_b128 v106, v[168:171] offset:10240
  ds_write_b128 v106, v[172:175] offset:11264
  ds_write_b128 v106, v[176:179] offset:12288
  ds_write_b128 v106, v[180:183] offset:13312
  ds_write_b128 v106, v[184:187] offset:14336
  ds_write_b128 v106, v[188:191] offset:15360
  ds_write_b128 v106, v[192:195] offset:16384
  ds_write_b128 v106, v[196:199] offset:17408
  ds_write_b128 v106, v[200:203] offset:18432
  ds_write_b128 v106, v[204:207] offset:19456
  ds_write_b128 v106, v[208:211] offset:20480
  ds_write_b128 v106, v[212:215] offset:21504
  ds_write_b128 v106, v[216:219] offset:22528
  ds_write_b128 v106, v[220:223] offset:23552
  ds_write_b128 v106, v[224:227] offset:24576
  ds_write_b128 v106, v[228:231] offset:25600
  ds_write_b128 v106, v[232:235] offset:26624
  ds_write_b128 v106, v[236:239] offset:27648
  ds_write_b128 v106, v[240:243] offset:28672
  ds_write_b128 v106, v[244:247] offset:29696
  ds_write_b128 v106, v[248:251] offset:30720
  ds_write_b128 v106, v[252:255] offset:31744
  s_lshl_b32 s53, s3, 2
  s_add_u32 s53, s53, 98480
  v_mov_b32 v116, s53
  v_mov_b32 v95, 1
  s_waitcnt lgkmcnt(0)
  s_mov_b64 exec, 1
  ds_write_b32 v116, v95 offset:0
  s_mov_b64 exec, -1
  s_cmp_eq_u32 s3, s78
  s_cbranch_scc1 L_nomerge_c1
  s_lshl_b32 s54, s78, 2
  s_add_u32 s54, s54, 98480
  v_mov_b32 v116, s54
  s_xor_b32 s54, s3, s78
  s_lshl_b32 s54, s54, 13
  s_add_u32 s54, s54, 98304
  v_add_u32 v117, s54, v105
  s_lshl_b32 s55, s78, 9
  s_add_u32 s55, s55, 100352
L_w_done_c1:
  ds_read_b32 v95, v116 offset:0
  s_waitcnt lgkmcnt(0)
  v_readfirstlane_b32 s53, v95
  s_nop 0
  s_cmp_lg_u32 s53, 0
  s_cbranch_scc0 L_w_done_c1
  v_add_u32 v116, s55, v104
  ds_read_b64 v[102:103], v116
  ds_read_b128 v[160:163], v117 offset:0
  ds_read_b128 v[164:167], v117 offset:1024
  ds_read_b128 v[168:171], v117 offset:2048
  ds_read_b128 v[172:175], v117 offset:3072
  ds_read_b128 v[176:179], v117 offset:4096
  ds_read_b128 v[180:183], v117 offset:5120
  ds_read_b128 v[184:187], v117 offset:6144
  ds_read_b128 v[188:191], v117 offset:7168
  s_waitcnt lgkmcnt(8)
  v_max_f32 v45, v42, v102
  v_sub_f32 v98, v42, v45
  v_sub_f32 v100, v102, v45
  v_exp_f32 v98, v98
  v_exp_f32 v100, v100
  v_mov_b32 v42, v45
  v_mul_f32 v43, v43, v98
  v_fma_f32 v43, v103, v100, v43
  v_pk_mul_f32 v[128:129], v[128:129], v[98:99] op_sel_hi:[1,0]
  v_pk_mul_f32 v[130:131], v[130:131], v[98:99] op_sel_hi:[1,0]
  v_pk_mul_f32 v[132:133], v[132:133], v[98:99] op_sel_hi:[1,0]
  v_pk_mul_f32 v[134:135], v[134:135], v[98:99] op_sel_hi:[1,0]
  v_pk_mul_f32 v[136:137], v[136:137], v[98:99] op_sel_hi:[1,0]
  v_pk_mul_f32 v[138:139], v[138:139], v[98:99] op_sel_hi:[1,0]
  v_pk_mul_f32 v[140:141], v[140:141], v[98:99] op_sel_hi:[1,0]
  v_pk_mul_f32 v[142:143], v[142:143], v[98:99] op_sel_hi:[1,0]
  v_pk_mul_f32 v[144:145], v[144:145], v[98:99] op_sel_hi:[1,0]
  v_pk_mul_f32 v[146:147], v[146:147], v[98:99] op_sel_hi:[1,0]
  v_pk_mul_f32 v[148:149], v[148:149], v[98:99] op_sel_hi:[1,0]
  v_pk_mul_f32 v[150:151], v[150:151], v[98:99] op_sel_hi:[1,0]
  v_pk_mul_f32 v[152:153], v[152:153], v[98:99] op_sel_hi:[1,0]
  v_pk_mul_f32 v[154:155], v[154:155], v[98:99] op_sel_hi:[1,0]
  v_pk_mul_f32 v[156:157], v[156:157], v[98:99] op_sel_hi:[1,0]
  v_pk_mul_f32 v[158:159], v[158:159], v[98:99] op_sel_hi:[1,0]
  s_waitcnt lgkmcnt(0)
  v_pk_fma_f32 v[128:129], v[160:161], v[100:101], v[128:129] op_sel_hi:[1,0,1]
  v_pk_fma_f32 v[130:131], v[162:163], v[100:101], v[130:131] op_sel_hi:[1,0,1]
  v_pk_fma_f32 v[132:133], v[164:165], v[100:101], v[132:133] op_sel_hi:[1,0,1]
  v_pk_fma_f32 v[134:135], v[166:167], v[100:101], v[134:135] op_sel_hi:[1,0,1]
  v_pk_fma_f32 v[136:137], v[168:169], v[100:101], v[136:137] op_sel_hi:[1,0,1]
  v_pk_fma_f32 v[138:139], v[170:171], v[100:101], v[138:139] op_sel_hi:[1,0,1]
  v_pk_fma_f32 v[140:141], v[172:173], v[100:101], v[140:141] op_sel_hi:[1,0,1]
  v_pk_fma_f32 v[142:143], v[174:175], v[100:101], v[142:143] op_sel_hi:[1,0,1]
  v_pk_fma_f32 v[144:145], v[176:177], v[100:101], v[144:145] op_sel_hi:[1,0,1]
  v_pk_fma_f32 v[146:147], v[178:179], v[100:101], v[146:147] op_sel_hi:[1,0,1]
  v_pk_fma_f32 v[148:149], v[180:181], v[100:101], v[148:149] op_sel_hi:[1,0,1]
  v_pk_fma_f32 v[150:151], v[182:183], v[100:101], v[150:151] op_sel_hi:[1,0,1]
  v_pk_fma_f32 v[152:153], v[184:185], v[100:101], v[152:153] op_sel_hi:[1,0,1]
  v_pk_fma_f32 v[154:155], v[186:187], v[100:101], v[154:155] op_sel_hi:[1,0,1]
  v_pk_fma_f32 v[156:157], v[188:189], v[100:101], v[156:157] op_sel_hi:[1,0,1]
  v_pk_fma_f32 v[158:159], v[190:191], v[100:101], v[158:159] op_sel_hi:[1,0,1]
L_nomerge_c1:
  s_cmp_eq_u32 s3, s79
  s_cbranch_scc1 L_nomerge_c2
  s_lshl_b32 s54, s79, 2
  s_add_u32 s54, s54, 98480
  v_mov_b32 v116, s54
  s_xor_b32 s54, s3, s79
  s_lshl_b32 s54, s54, 13
  s_lshl_b32 s55, s79, 15
  s_add_u32 s54, s54, s55
  v_add_u32 v117, s54, v105
  s_lshl_b32 s55, s79, 9
  s_add_u32 s55, s55, 100352
L_w_done_c2:
  ds_read_b32 v95, v116 offset:0
  s_waitcnt lgkmcnt(0)
  v_readfirstlane_b32 s53, v95
  s_nop 0
  s_cmp_lg_u32 s53, 0
  s_cbranch_scc0 L_w_done_c2
  v_add_u32 v116, s55, v104
  ds_read_b64 v[102:103], v116
  ds_read_b128 v[160:163], v117 offset:0
  ds_read_b128 v[164:167], v117 offset:1024
  ds_read_b128 v[168:171], v117 offset:2048
  ds_read_b128 v[172:175], v117 offset:3072
  ds_read_b128 v[176:179], v117 offset:4096
  ds_read_b128 v[180:183], v117 offset:5120
  ds_read_b128 v[184:187], v117 offset:6144
  ds_read_b128 v[188:191], v117 offset:7168
  s_waitcnt lgkmcnt(8)
  v_max_f32 v45, v42, v102
  v_sub_f32 v98, v42, v45
  v_sub_f32 v100, v102, v45
  v_exp_f32 v98, v98
  v_exp_f32 v100, v100
  v_mov_b32 v42, v45
  v_mul_f32 v43, v43, v98
  v_fma_f32 v43, v103, v100, v43
  v_pk_mul_f32 v[128:129], v[128:129], v[98:99] op_sel_hi:[1,0]
  v_pk_mul_f32 v[130:131], v[130:131], v[98:99] op_sel_hi:[1,0]
  v_pk_mul_f32 v[132:133], v[132:133], v[98:99] op_sel_hi:[1,0]
  v_pk_mul_f32 v[134:135], v[134:135], v[98:99] op_sel_hi:[1,0]
  v_pk_mul_f32 v[136:137], v[136:137], v[98:99] op_sel_hi:[1,0]
  v_pk_mul_f32 v[138:139], v[138:139], v[98:99] op_sel_hi:[1,0]
  v_pk_mul_f32 v[140:141], v[140:141], v[98:99] op_sel_hi:[1,0]
  v_pk_mul_f32 v[142:143], v[142:143], v[98:99] op_sel_hi:[1,0]
  v_pk_mul_f32 v[144:145], v[144:145], v[98:99] op_sel_hi:[1,0]
  v_pk_mul_f32 v[146:147], v[146:147], v[98:99] op_sel_hi:[1,0]
  v_pk_mul_f32 v[148:149], v[148:149], v[98:99] op_sel_hi:[1,0]
  v_pk_mul_f32 v[150:151], v[150:151], v[98:99] op_sel_hi:[1,0]
  v_pk_mul_f32 v[152:153], v[152:153], v[98:99] op_sel_hi:[1,0]
  v_pk_mul_f32 v[154:155], v[154:155], v[98:99] op_sel_hi:[1,0]
  v_pk_mul_f32 v[156:157], v[156:157], v[98:99] op_sel_hi:[1,0]
  v_pk_mul_f32 v[158:159], v[158:159], v[98:99] op_sel_hi:[1,0]
  s_waitcnt lgkmcnt(0)
  v_pk_fma_f32 v[128:129], v[160:161], v[100:101], v[128:129] op_sel_hi:[1,0,1]
  v_pk_fma_f32 v[130:131], v[162:163], v[100:101], v[130:131] op_sel_hi:[1,0,1]
  v_pk_fma_f32 v[132:133], v[164:165], v[100:101], v[132:133] op_sel_hi:[1,0,1]
  v_pk_fma_f32 v[134:135], v[166:167], v[100:101], v[134:135] op_sel_hi:[1,0,1]
  v_pk_fma_f32 v[136:137], v[168:169], v[100:101], v[136:137] op_sel_hi:[1,0,1]
  v_pk_fma_f32 v[138:139], v[170:171], v[100:101], v[138:139] op_sel_hi:[1,0,1]
  v_pk_fma_f32 v[140:141], v[172:173], v[100:101], v[140:141] op_sel_hi:[1,0,1]
  v_pk_fma_f32 v[142:143], v[174:175], v[100:101], v[142:143] op_sel_hi:[1,0,1]
  v_pk_fma_f32 v[144:145], v[176:177], v[100:101], v[144:145] op_sel_hi:[1,0,1]
  v_pk_fma_f32 v[146:147], v[178:179], v[100:101], v[146:147] op_sel_hi:[1,0,1]
  v_pk_fma_f32 v[148:149], v[180:181], v[100:101], v[148:149] op_sel_hi:[1,0,1]
  v_pk_fma_f32 v[150:151], v[182:183], v[100:101], v[150:151] op_sel_hi:[1,0,1]
  v_pk_fma_f32 v[152:153], v[184:185], v[100:101], v[152:153] op_sel_hi:[1,0,1]
  v_pk_fma_f32 v[154:155], v[186:187], v[100:101], v[154:155] op_sel_hi:[1,0,1]
  v_pk_fma_f32 v[156:157], v[188:189], v[100:101], v[156:157] op_sel_hi:[1,0,1]
  v_pk_fma_f32 v[158:159], v[190:191], v[100:101], v[158:159] op_sel_hi:[1,0,1]
L_nomerge_c2:
  s_cmp_eq_u32 s3, s78
  s_cbranch_scc0 L_not_last
L_w_kl:
  ds_read_b32 v95, v92 offset:0
  s_waitcnt lgkmcnt(0)
  v_readfirstlane_b32 s53, v95
  s_nop 0
  s_cmp_gt_u32 s53, s58
  s_cbranch_scc0 L_w_kl
  ds_read_b128 a[64:67], v18 offset:0
  ds_read_b128 a[68:71], v19 offset:0
  ds_read_b128 a[72:75], v20 offset:0
  ds_read_b128 a[76:79], v21 offset:0
  ds_read_b128 a[80:83], v22 offset:0
  ds_read_b128 a[84:87], v23 offset:0
  ds_read_b128 a[88:91], v24 offset:0
  ds_read_b128 a[92:95], v25 offset:0
  ds_read_b128 a[96:99], v18 offset:256
  ds_read_b128 a[100:103], v19 offset:256
  ds_read_b128 a[104:107], v20 offset:256
  ds_read_b128 a[108:111], v21 offset:256
  s_waitcnt lgkmcnt(11)
  v_mfma_f32_32x32x16_bf16 v[48:63], a[64:67], a[0:3], 0
  ds_read_b128 a[112:115], v22 offset:256
  s_waitcnt lgkmcnt(11)
  v_mfma_f32_32x32x16_bf16 v[48:63], a[68:71], a[4:7], v[48:63]
  ds_read_b128 a[116:119], v23 offset:256
  s_waitcnt lgkmcnt(11)
  v_mfma_f32_32x32x16_bf16 v[48:63], a[72:75], a[8:11], v[48:63]
  ds_read_b128 a[120:123], v24 offset:256
  s_waitcnt lgkmcnt(11)
  v_mfma_f32_32x32x16_bf16 v[48:63], a[76:79], a[12:15], v[48:63]
  ds_read_b128 a[124:127], v25 offset:256
  s_waitcnt lgkmcnt(11)
  v_mfma_f32_32x32x16_bf16 v[48:63], a[80:83], a[16:19], v[48:63]
  s_waitcnt lgkmcnt(10)
  v_mfma_f32_32x32x16_bf16 v[48:63], a[84:87], a[20:23], v[48:63]
  s_waitcnt lgkmcnt(9)
  v_mfma_f32_32x32x16_bf16 v[48:63], a[88:91], a[24:27], v[48:63]
  s_waitcnt lgkmcnt(8)
  v_mfma_f32_32x32x16_bf16 v[48:63], a[92:95], a[28:31], v[48:63]
  s_waitcnt lgkmcnt(7)
  v_mfma_f32_32x32x16_bf16 v[48:63], a[96:99], a[32:35], v[48:63]
  s_waitcnt lgkmcnt(6)
  v_mfma_f32_32x32x16_bf16 v[48:63], a[100:103], a[36:39], v[48:63]
  s_waitcnt lgkmcnt(5)
  v_mfma_f32_32x32x16_bf16 v[48:63], a[104:107], a[40:43], v[48:63]
  s_waitcnt lgkmcnt(4)
  v_mfma_f32_32x32x16_bf16 v[48:63], a[108:111], a[44:47], v[48:63]
  s_waitcnt lgkmcnt(3)
  v_mfma_f32_32x32x16_bf16 v[48:63], a[112:115], a[48:51], v[48:63]
  s_waitcnt lgkmcnt(2)
  v_mfma_f32_32x32x16_bf16 v[48:63], a[116:119], a[52:55], v[48:63]
  s_waitcnt lgkmcnt(1)
  v_mfma_f32_32x32x16_bf16 v[48:63], a[120:123], a[56:59], v[48:63]
  s_waitcnt lgkmcnt(0)
  v_mfma_f32_32x32x16_bf16 v[48:63], a[124:127], a[60:63], v[48:63]
  s_nop 7
  s_nop 4
  v_max3_f32 v46, v48, v49, v50
  v_max3_f32 v46, v46, v51, v52
  v_max3_f32 v46, v46, v53, v54
  v_max3_f32 v46, v46, v55, v56
  v_max3_f32 v46, v46, v57, v58
  v_max3_f32 v46, v46, v59, v60
  v_max3_f32 v46, v46, v61, v62
  v_max_f32 v46, v46, v63
  v_mov_b32 v47, v46
  s_nop 1
  v_permlane32_swap_b32 v46, v47
  v_max_f32 v46, v46, v47
  v_mul_f32 v118, s50, v46
  v_fma_f32 v48, v48, s50, -v118
  v_fma_f32 v49, v49, s50, -v118
  v_fma_f32 v50, v50, s50, -v118
  v_fma_f32 v51, v51, s50, -v118
  v_fma_f32 v52, v52, s50, -v118
  v_fma_f32 v53, v53, s50, -v118
  v_fma_f32 v54, v54, s50, -v118
  v_fma_f32 v55, v55, s50, -v118
  v_fma_f32 v56, v56, s50, -v118
  v_fma_f32 v57, v57, s50, -v118
  v_fma_f32 v58, v58, s50, -v118
  v_fma_f32 v59, v59, s50, -v118
  v_fma_f32 v60, v60, s50, -v118
  v_fma_f32 v61, v61, s50, -v118
  v_fma_f32 v62, v62, s50, -v118
  v_fma_f32 v63, v63, s50, -v118
  v_exp_f32 v48, v48
  v_exp_f32 v49, v49
  v_exp_f32 v50, v50
  v_exp_f32 v51, v51
  v_exp_f32 v52, v52
  v_exp_f32 v53, v53
  v_exp_f32 v54, v54
  v_exp_f32 v55, v55
  v_exp_f32 v56, v56
  v_exp_f32 v57, v57
  v_exp_f32 v58, v58
  v_exp_f32 v59, v59
  v_exp_f32 v60, v60
  v_exp_f32 v61, v61
  v_exp_f32 v62, v62
  v_exp_f32 v63, v63
  s_nop 0
  v_add_f32 v46, v48, v49
  v_add_f32 v47, v50, v51
  v_add_f32 v46, v46, v52
  v_add_f32 v46, v46, v53
  v_add_f32 v47, v47, v54
  v_add_f32 v47, v47, v55
  v_add_f32 v46, v46, v56
  v_add_f32 v46, v46, v57
  v_add_f32 v47, v47, v58
  v_add_f32 v47, v47, v59
  v_add_f32 v46, v46, v60
  v_add_f32 v46, v46, v61
  v_add_f32 v47, v47, v62
  v_add_f32 v47, v47, v63
  v_cvt_pk_bf16_f32 v64, v48, v49
  v_cvt_pk_bf16_f32 v65, v50, v51
  v_cvt_pk_bf16_f32 v66, v52, v53
  v_cvt_pk_bf16_f32 v67, v54, v55
  v_cvt_pk_bf16_f32 v68, v56, v57
  v_cvt_pk_bf16_f32 v69, v58, v59
  v_cvt_pk_bf16_f32 v70, v60, v61
  v_cvt_pk_bf16_f32 v71, v62, v63
  v_add_f32 v46, v46, v47
  ds_write_b128 v110, v[64:67]
  ds_write_b128 v110, v[68:71] offset:1024
  v_mov_b32 v47, v46
  s_nop 1
  v_permlane32_swap_b32 v46, v47
  v_add_f32 v119, v46, v47
  ds_write_b64 v111, v[118:119]
  v_mov_b32 v116, 98496
  v_mov_b32 v95, 1
  s_waitcnt lgkmcnt(0)
  s_mov_b64 exec, 1
  ds_write_b32 v116, v95 offset:0
  s_mov_b64 exec, -1
  ds_read2_b32 v[96:97], v109 offset0:0 offset1:2
  s_waitcnt lgkmcnt(0)
  v_readfirstlane_b32 s80, v96
  v_readfirstlane_b32 s56, v97
  s_nop 1
  s_cmp_eq_u32 s80, 2
  s_cselect_b32 s56, s56, 0
  s_cmp_eq_u32 s48, 0
  s_cselect_b32 s56, s56, 0
  s_cmp_eq_u32 s56, 0
  s_cbranch_scc1 L_nopf_s
  s_mov_b32 s48, 1
  buffer_load_dwordx4 v[8:11], v105, s[36:39], 0 offen offset:0 sc1
  buffer_load_dwordx4 v[12:15], v105, s[36:39], 0 offen offset:1024 sc1
  buffer_load_dwordx4 v[16:19], v105, s[36:39], 0 offen offset:2048 sc1
  buffer_load_dwordx4 v[20:23], v105, s[36:39], 0 offen offset:3072 sc1
  buffer_load_dwordx4 v[24:27], v105, s[36:39], s40 offen offset:0 sc1
  buffer_load_dwordx4 v[28:31], v105, s[36:39], s40 offen offset:1024 sc1
  buffer_load_dwordx4 v[32:35], v105, s[36:39], s40 offen offset:2048 sc1
  buffer_load_dwordx4 v[36:39], v105, s[36:39], s40 offen offset:3072 sc1
  buffer_load_dwordx2 v[40:41], v104, s[36:39], s41 offen sc1
L_nopf_s:
  s_lshl_b32 s54, s78, 4
  s_add_u32 s54, s54, 98304
  v_mov_b32 v116, s54
L_w_vl_s:
  ds_read_b32 v95, v116 offset:8
  s_waitcnt lgkmcnt(0)
  v_readfirstlane_b32 s53, v95
  s_nop 0
  s_cmp_gt_u32 s53, s58
  s_cbranch_scc0 L_w_vl_s
  ds_read_b64_tr_b16 a[128:129], v112 offset:0
  ds_read_b64_tr_b16 a[130:131], v113 offset:4096
  ds_read_b64_tr_b16 a[132:133], v114 offset:0
  ds_read_b64_tr_b16 a[134:135], v115 offset:4096
  ds_read_b64_tr_b16 a[136:137], v112 offset:8192
  ds_read_b64_tr_b16 a[138:139], v113 offset:12288
  ds_read_b64_tr_b16 a[140:141], v114 offset:8192
  ds_read_b64_tr_b16 a[142:143], v115 offset:12288
  s_waitcnt lgkmcnt(6)
  v_mfma_f32_32x32x16_bf16 v[160:175], a[128:131], v[64:67], 0
  s_waitcnt lgkmcnt(4)
  v_mfma_f32_32x32x16_bf16 v[176:191], a[132:135], v[64:67], 0
  s_waitcnt lgkmcnt(2)
  v_mfma_f32_32x32x16_bf16 v[160:175], a[136:139], v[68:71], v[160:175]
  s_waitcnt lgkmcnt(0)
  v_mfma_f32_32x32x16_bf16 v[176:191], a[140:143], v[68:71], v[176:191]
  s_cmp_eq_u32 s3, s81
  s_cbranch_scc1 L_nomerge_s3
  s_lshl_b32 s54, s81, 2
  s_add_u32 s54, s54, 98480
  v_mov_b32 v116, s54
  s_xor_b32 s54, s3, s81
  s_lshl_b32 s54, s54, 13
  s_lshl_b32 s55, s81, 15
  s_add_u32 s54, s54, s55
  v_add_u32 v117, s54, v105
  s_lshl_b32 s55, s81, 9
  s_add_u32 s55, s55, 100352
L_w_done_s3:
  ds_read_b32 v95, v116 offset:0
  s_waitcnt lgkmcnt(0)
  v_readfirstlane_b32 s53, v95
  s_nop 0
  s_cmp_lg_u32 s53, 0
  s_cbranch_scc0 L_w_done_s3
  v_add_u32 v116, s55, v104
  ds_read_b64 v[102:103], v116
  ds_read_b128 v[192:195], v117 offset:0
  ds_read_b128 v[196:199], v117 offset:1024
  ds_read_b128 v[200:203], v117 offset:2048
  ds_read_b128 v[204:207], v117 offset:3072
  ds_read_b128 v[208:211], v117 offset:4096
  ds_read_b128 v[212:215], v117 offset:5120
  ds_read_b128 v[216:219], v117 offset:6144
  ds_read_b128 v[220:223], v117 offset:7168
  s_waitcnt lgkmcnt(8)
  v_max_f32 v45, v42, v102
  v_sub_f32 v98, v42, v45
  v_sub_f32 v100, v102, v45
  v_exp_f32 v98, v98
  v_exp_f32 v100, v100
  v_mov_b32 v42, v45
  v_mul_f32 v43, v43, v98
  v_fma_f32 v43, v103, v100, v43
  v_pk_mul_f32 v[128:129], v[128:129], v[98:99] op_sel_hi:[1,0]
  v_pk_mul_f32 v[130:131], v[130:131], v[98:99] op_sel_hi:[1,0]
  v_pk_mul_f32 v[132:133], v[132:133], v[98:99] op_sel_hi:[1,0]
  v_pk_mul_f32 v[134:135], v[134:135], v[98:99] op_sel_hi:[1,0]
  v_pk_mul_f32 v[136:137], v[136:137], v[98:99] op_sel_hi:[1,0]
  v_pk_mul_f32 v[138:139], v[138:139], v[98:99] op_sel_hi:[1,0]
  v_pk_mul_f32 v[140:141], v[140:141], v[98:99] op_sel_hi:[1,0]
  v_pk_mul_f32 v[142:143], v[142:143], v[98:99] op_sel_hi:[1,0]
  v_pk_mul_f32 v[144:145], v[144:145], v[98:99] op_sel_hi:[1,0]
  v_pk_mul_f32 v[146:147], v[146:147], v[98:99] op_sel_hi:[1,0]
  v_pk_mul_f32 v[148:149], v[148:149], v[98:99] op_sel_hi:[1,0]
  v_pk_mul_f32 v[150:151], v[150:151], v[98:99] op_sel_hi:[1,0]
  v_pk_mul_f32 v[152:153], v[152:153], v[98:99] op_sel_hi:[1,0]
  v_pk_mul_f32 v[154:155], v[154:155], v[98:99] op_sel_hi:[1,0]
  v_pk_mul_f32 v[156:157], v[156:157], v[98:99] op_sel_hi:[1,0]
  v_pk_mul_f32 v[158:159], v[158:159], v[98:99] op_sel_hi:[1,0]
  s_waitcnt lgkmcnt(0)
  v_pk_fma_f32 v[128:129], v[192:193], v[100:101], v[128:129] op_sel_hi:[1,0,1]
  v_pk_fma_f32 v[130:131], v[194:195], v[100:101], v[130:131] op_sel_hi:[1,0,1]
  v_pk_fma_f32 v[132:133], v[196:197], v[100:101], v[132:133] op_sel_hi:[1,0,1]
  v_pk_fma_f32 v[134:135], v[198:199], v[100:101], v[134:135] op_sel_hi:[1,0,1]
  v_pk_fma_f32 v[136:137], v[200:201], v[100:101], v[136:137] op_sel_hi:[1,0,1]
  v_pk_fma_f32 v[138:139], v[202:203], v[100:101], v[138:139] op_sel_hi:[1,0,1]
  v_pk_fma_f32 v[140:141], v[204:205], v[100:101], v[140:141] op_sel_hi:[1,0,1]
  v_pk_fma_f32 v[142:143], v[206:207], v[100:101], v[142:143] op_sel_hi:[1,0,1]
  v_pk_fma_f32 v[144:145], v[208:209], v[100:101], v[144:145] op_sel_hi:[1,0,1]
  v_pk_fma_f32 v[146:147], v[210:211], v[100:101], v[146:147] op_sel_hi:[1,0,1]
  v_pk_fma_f32 v[148:149], v[212:213], v[100:101], v[148:149] op_sel_hi:[1,0,1]
  v_pk_fma_f32 v[150:151], v[214:215], v[100:101], v[150:151] op_sel_hi:[1,0,1]
  v_pk_fma_f32 v[152:153], v[216:217], v[100:101], v[152:153] op_sel_hi:[1,0,1]
  v_pk_fma_f32 v[154:155], v[218:219], v[100:101], v[154:155] op_sel_hi:[1,0,1]
  v_pk_fma_f32 v[156:157], v[220:221], v[100:101], v[156:157] op_sel_hi:[1,0,1]
  v_pk_fma_f32 v[158:159], v[222:223], v[100:101], v[158:159] op_sel_hi:[1,0,1]
L_nomerge_s3:
  v_mov_b32 v102, v118
  v_mov_b32 v103, v119
  v_max_f32 v45, v42, v102
  v_sub_f32 v98, v42, v45
  v_sub_f32 v100, v102, v45
  v_exp_f32 v98, v98
  v_exp_f32 v100, v100
  v_mov_b32 v42, v45
  v_mul_f32 v43, v43, v98
  v_fma_f32 v43, v103, v100, v43
  v_pk_mul_f32 v[128:129], v[128:129], v[98:99] op_sel_hi:[1,0]
  v_pk_mul_f32 v[130:131], v[130:131], v[98:99] op_sel_hi:[1,0]
  v_pk_mul_f32 v[132:133], v[132:133], v[98:99] op_sel_hi:[1,0]
  v_pk_mul_f32 v[134:135], v[134:135], v[98:99] op_sel_hi:[1,0]
  v_pk_mul_f32 v[136:137], v[136:137], v[98:99] op_sel_hi:[1,0]
  v_pk_mul_f32 v[138:139], v[138:139], v[98:99] op_sel_hi:[1,0]
  v_pk_mul_f32 v[140:141], v[140:141], v[98:99] op_sel_hi:[1,0]
  v_pk_mul_f32 v[142:143], v[142:143], v[98:99] op_sel_hi:[1,0]
  v_pk_mul_f32 v[144:145], v[144:145], v[98:99] op_sel_hi:[1,0]
  v_pk_mul_f32 v[146:147], v[146:147], v[98:99] op_sel_hi:[1,0]
  v_pk_mul_f32 v[148:149], v[148:149], v[98:99] op_sel_hi:[1,0]
  v_pk_mul_f32 v[150:151], v[150:151], v[98:99] op_sel_hi:[1,0]
  v_pk_mul_f32 v[152:153], v[152:153], v[98:99] op_sel_hi:[1,0]
  v_pk_mul_f32 v[154:155], v[154:155], v[98:99] op_sel_hi:[1,0]
  v_pk_mul_f32 v[156:157], v[156:157], v[98:99] op_sel_hi:[1,0]
  v_pk_mul_f32 v[158:159], v[158:159], v[98:99] op_sel_hi:[1,0]
  s_branch L_slice_done
L_not_last:
  s_cmp_eq_u32 s3, s81
  s_cbranch_scc1 L_nomerge_c3
  s_lshl_b32 s54, s81, 2
  s_add_u32 s54, s54, 98480
  v_mov_b32 v116, s54
  s_xor_b32 s54, s3, s81
  s_lshl_b32 s54, s54, 13
  s_lshl_b32 s55, s81, 15
  s_add_u32 s54, s54, s55
  v_add_u32 v117, s54, v105
  s_lshl_b32 s55, s81, 9
  s_add_u32 s55, s55, 100352
L_w_done_c3:
  ds_read_b32 v95, v116 offset:0
  s_waitcnt lgkmcnt(0)
  v_readfirstlane_b32 s53, v95
  s_nop 0
  s_cmp_lg_u32 s53, 0
  s_cbranch_scc0 L_w_done_c3
  v_add_u32 v116, s55, v104
  ds_read_b64 v[102:103], v116
  ds_read_b128 v[160:163], v117 offset:0
  ds_read_b128 v[164:167], v117 offset:1024
  ds_read_b128 v[168:171], v117 offset:2048
  ds_read_b128 v[172:175], v117 offset:3072
  ds_read_b128 v[176:179], v117 offset:4096
  ds_read_b128 v[180:183], v117 offset:5120
  ds_read_b128 v[184:187], v117 offset:6144
  ds_read_b128 v[188:191], v117 offset:7168
  s_waitcnt lgkmcnt(8)
  v_max_f32 v45, v42, v102
  v_sub_f32 v98, v42, v45
  v_sub_f32 v100, v102, v45
  v_exp_f32 v98, v98
  v_exp_f32 v100, v100
  v_mov_b32 v42, v45
  v_mul_f32 v43, v43, v98
  v_fma_f32 v43, v103, v100, v43
  v_pk_mul_f32 v[128:129], v[128:129], v[98:99] op_sel_hi:[1,0]
  v_pk_mul_f32 v[130:131], v[130:131], v[98:99] op_sel_hi:[1,0]
  v_pk_mul_f32 v[132:133], v[132:133], v[98:99] op_sel_hi:[1,0]
  v_pk_mul_f32 v[134:135], v[134:135], v[98:99] op_sel_hi:[1,0]
  v_pk_mul_f32 v[136:137], v[136:137], v[98:99] op_sel_hi:[1,0]
  v_pk_mul_f32 v[138:139], v[138:139], v[98:99] op_sel_hi:[1,0]
  v_pk_mul_f32 v[140:141], v[140:141], v[98:99] op_sel_hi:[1,0]
  v_pk_mul_f32 v[142:143], v[142:143], v[98:99] op_sel_hi:[1,0]
  v_pk_mul_f32 v[144:145], v[144:145], v[98:99] op_sel_hi:[1,0]
  v_pk_mul_f32 v[146:147], v[146:147], v[98:99] op_sel_hi:[1,0]
  v_pk_mul_f32 v[148:149], v[148:149], v[98:99] op_sel_hi:[1,0]
  v_pk_mul_f32 v[150:151], v[150:151], v[98:99] op_sel_hi:[1,0]
  v_pk_mul_f32 v[152:153], v[152:153], v[98:99] op_sel_hi:[1,0]
  v_pk_mul_f32 v[154:155], v[154:155], v[98:99] op_sel_hi:[1,0]
  v_pk_mul_f32 v[156:157], v[156:157], v[98:99] op_sel_hi:[1,0]
  v_pk_mul_f32 v[158:159], v[158:159], v[98:99] op_sel_hi:[1,0]
  s_waitcnt lgkmcnt(0)
  v_pk_fma_f32 v[128:129], v[160:161], v[100:101], v[128:129] op_sel_hi:[1,0,1]
  v_pk_fma_f32 v[130:131], v[162:163], v[100:101], v[130:131] op_sel_hi:[1,0,1]
  v_pk_fma_f32 v[132:133], v[164:165], v[100:101], v[132:133] op_sel_hi:[1,0,1]
  v_pk_fma_f32 v[134:135], v[166:167], v[100:101], v[134:135] op_sel_hi:[1,0,1]
  v_pk_fma_f32 v[136:137], v[168:169], v[100:101], v[136:137] op_sel_hi:[1,0,1]
  v_pk_fma_f32 v[138:139], v[170:171], v[100:101], v[138:139] op_sel_hi:[1,0,1]
  v_pk_fma_f32 v[140:141], v[172:173], v[100:101], v[140:141] op_sel_hi:[1,0,1]
  v_pk_fma_f32 v[142:143], v[174:175], v[100:101], v[142:143] op_sel_hi:[1,0,1]
  v_pk_fma_f32 v[144:145], v[176:177], v[100:101], v[144:145] op_sel_hi:[1,0,1]
  v_pk_fma_f32 v[146:147], v[178:179], v[100:101], v[146:147] op_sel_hi:[1,0,1]
  v_pk_fma_f32 v[148:149], v[180:181], v[100:101], v[148:149] op_sel_hi:[1,0,1]
  v_pk_fma_f32 v[150:151], v[182:183], v[100:101], v[150:151] op_sel_hi:[1,0,1]
  v_pk_fma_f32 v[152:153], v[184:185], v[100:101], v[152:153] op_sel_hi:[1,0,1]
  v_pk_fma_f32 v[154:155], v[186:187], v[100:101], v[154:155] op_sel_hi:[1,0,1]
  v_pk_fma_f32 v[156:157], v[188:189], v[100:101], v[156:157] op_sel_hi:[1,0,1]
  v_pk_fma_f32 v[158:159], v[190:191], v[100:101], v[158:159] op_sel_hi:[1,0,1]
L_nomerge_c3:
  s_cmp_eq_u32 s3, s79
  s_cbranch_scc0 L_slice
  ds_read2_b32 v[96:97], v109 offset0:0 offset1:2
  s_waitcnt lgkmcnt(0)
  v_readfirstlane_b32 s54, v96
  v_readfirstlane_b32 s55, v97
  s_nop 1
  s_cmp_eq_u32 s54, 2
  s_cbranch_scc0 L_slice
  s_cmp_eq_u32 s55, 0
  s_cbranch_scc0 L_slice
  s_mov_b32 s99, 0
  s_atomic_add s99, s[96:97], 0x0 glc
  s_waitcnt lgkmcnt(0)
  s_lshr_b32 s99, s99, s88
  s_and_b32 s53, s99, 16
  s_cbranch_scc0 L_slice
  v_mov_b32 v95, 1
  s_mov_b64 exec, 1
  ds_write_b32 v109, v95 offset:8
  s_mov_b64 exec, -1
L_slice:
  ds_read2_b32 v[96:97], v109 offset0:0 offset1:2
  s_waitcnt lgkmcnt(0)
  v_readfirstlane_b32 s80, v96
  v_readfirstlane_b32 s56, v97
  s_nop 1
  s_cmp_eq_u32 s80, 2
  s_cselect_b32 s56, s56, 0
  s_cmp_eq_u32 s48, 0
  s_cselect_b32 s56, s56, 0
  s_cmp_eq_u32 s56, 0
  s_cbranch_scc1 L_nopf_a
  s_mov_b32 s48, 1
  buffer_load_dwordx4 v[8:11], v105, s[36:39], 0 offen offset:0 sc1
  buffer_load_dwordx4 v[12:15], v105, s[36:39], 0 offen offset:1024 sc1
  buffer_load_dwordx4 v[16:19], v105, s[36:39], 0 offen offset:2048 sc1
  buffer_load_dwordx4 v[20:23], v105, s[36:39], 0 offen offset:3072 sc1
  buffer_load_dwordx4 v[24:27], v105, s[36:39], s40 offen offset:0 sc1
  buffer_load_dwordx4 v[28:31], v105, s[36:39], s40 offen offset:1024 sc1
  buffer_load_dwordx4 v[32:35], v105, s[36:39], s40 offen offset:2048 sc1
  buffer_load_dwordx4 v[36:39], v105, s[36:39], s40 offen offset:3072 sc1
  buffer_load_dwordx2 v[40:41], v104, s[36:39], s41 offen sc1
L_nopf_a:
  v_mov_b32 v116, 98496
L_w_p:
  ds_read_b32 v95, v116 offset:0
  s_waitcnt lgkmcnt(0)
  v_readfirstlane_b32 s53, v95
  s_nop 0
  s_cmp_lg_u32 s53, 0
  s_cbranch_scc0 L_w_p
  ds_read_b64 v[102:103], v111
  ds_read_b128 v[64:67], v110
  ds_read_b128 v[68:71], v110 offset:1024
  s_waitcnt lgkmcnt(0)
  v_max_f32 v45, v42, v102
  v_sub_f32 v98, v42, v45
  v_sub_f32 v100, v102, v45
  v_exp_f32 v98, v98
  v_exp_f32 v100, v100
  v_mov_b32 v42, v45
  v_mul_f32 v43, v43, v98
  v_fma_f32 v43, v103, v100, v43
  v_pk_mul_f32 v[128:129], v[128:129], v[98:99] op_sel_hi:[1,0]
  v_pk_mul_f32 v[130:131], v[130:131], v[98:99] op_sel_hi:[1,0]
  v_pk_mul_f32 v[132:133], v[132:133], v[98:99] op_sel_hi:[1,0]
  v_pk_mul_f32 v[134:135], v[134:135], v[98:99] op_sel_hi:[1,0]
  v_pk_mul_f32 v[136:137], v[136:137], v[98:99] op_sel_hi:[1,0]
  v_pk_mul_f32 v[138:139], v[138:139], v[98:99] op_sel_hi:[1,0]
  v_pk_mul_f32 v[140:141], v[140:141], v[98:99] op_sel_hi:[1,0]
  v_pk_mul_f32 v[142:143], v[142:143], v[98:99] op_sel_hi:[1,0]
  v_pk_mul_f32 v[144:145], v[144:145], v[98:99] op_sel_hi:[1,0]
  v_pk_mul_f32 v[146:147], v[146:147], v[98:99] op_sel_hi:[1,0]
  v_pk_mul_f32 v[148:149], v[148:149], v[98:99] op_sel_hi:[1,0]
  v_pk_mul_f32 v[150:151], v[150:151], v[98:99] op_sel_hi:[1,0]
  v_pk_mul_f32 v[152:153], v[152:153], v[98:99] op_sel_hi:[1,0]
  v_pk_mul_f32 v[154:155], v[154:155], v[98:99] op_sel_hi:[1,0]
  v_pk_mul_f32 v[156:157], v[156:157], v[98:99] op_sel_hi:[1,0]
  v_pk_mul_f32 v[158:159], v[158:159], v[98:99] op_sel_hi:[1,0]
  s_lshl_b32 s54, s78, 4
  s_add_u32 s54, s54, 98304
  v_mov_b32 v116, s54
L_w_vl_a:
  ds_read_b32 v95, v116 offset:8
  s_waitcnt lgkmcnt(0)
  v_readfirstlane_b32 s53, v95
  s_nop 0
  s_cmp_gt_u32 s53, s58
  s_cbranch_scc0 L_w_vl_a
  ds_read_b64_tr_b16 a[128:129], v112 offset:0
  ds_read_b64_tr_b16 a[130:131], v113 offset:4096
  ds_read_b64_tr_b16 a[132:133], v114 offset:0
  ds_read_b64_tr_b16 a[134:135], v115 offset:4096
  ds_read_b64_tr_b16 a[136:137], v112 offset:8192
  ds_read_b64_tr_b16 a[138:139], v113 offset:12288
  ds_read_b64_tr_b16 a[140:141], v114 offset:8192
  ds_read_b64_tr_b16 a[142:143], v115 offset:12288
  s_waitcnt lgkmcnt(6)
  v_mfma_f32_32x32x16_bf16 v[160:175], a[128:131], v[64:67], 0
  s_waitcnt lgkmcnt(4)
  v_mfma_f32_32x32x16_bf16 v[176:191], a[132:135], v[64:67], 0
  s_waitcnt lgkmcnt(2)
  v_mfma_f32_32x32x16_bf16 v[160:175], a[136:139], v[68:71], v[160:175]
  s_waitcnt lgkmcnt(0)
  v_mfma_f32_32x32x16_bf16 v[176:191], a[140:143], v[68:71], v[176:191]
L_slice_done:
  ds_read2_b32 v[96:97], v109 offset0:0 offset1:2
  s_waitcnt lgkmcnt(0)
  v_readfirstlane_b32 s80, v96
  v_readfirstlane_b32 s56, v97
  s_nop 1
  s_cmp_eq_u32 s80, 2
  s_cselect_b32 s56, s56, 0
  s_cmp_eq_u32 s48, 0
  s_cselect_b32 s56, s56, 0
  s_cmp_eq_u32 s56, 0
  s_cbranch_scc1 L_nopf_b
  s_mov_b32 s48, 1
  buffer_load_dwordx4 v[8:11], v105, s[36:39], 0 offen offset:0 sc1
  buffer_load_dwordx4 v[12:15], v105, s[36:39], 0 offen offset:1024 sc1
  buffer_load_dwordx4 v[16:19], v105, s[36:39], 0 offen offset:2048 sc1
  buffer_load_dwordx4 v[20:23], v105, s[36:39], 0 offen offset:3072 sc1
  buffer_load_dwordx4 v[24:27], v105, s[36:39], s40 offen offset:0 sc1
  buffer_load_dwordx4 v[28:31], v105, s[36:39], s40 offen offset:1024 sc1
  buffer_load_dwordx4 v[32:35], v105, s[36:39], s40 offen offset:2048 sc1
  buffer_load_dwordx4 v[36:39], v105, s[36:39], s40 offen offset:3072 sc1
  buffer_load_dwordx2 v[40:41], v104, s[36:39], s41 offen sc1
L_nopf_b:
  s_nop 3
  v_pk_fma_f32 v[128:129], v[160:161], v[100:101], v[128:129] op_sel_hi:[1,0,1]
  v_pk_fma_f32 v[130:131], v[162:163], v[100:101], v[130:131] op_sel_hi:[1,0,1]
  v_pk_fma_f32 v[132:133], v[164:165], v[100:101], v[132:133] op_sel_hi:[1,0,1]
  v_pk_fma_f32 v[134:135], v[166:167], v[100:101], v[134:135] op_sel_hi:[1,0,1]
  v_pk_fma_f32 v[136:137], v[168:169], v[100:101], v[136:137] op_sel_hi:[1,0,1]
  v_pk_fma_f32 v[138:139], v[170:171], v[100:101], v[138:139] op_sel_hi:[1,0,1]
  v_pk_fma_f32 v[140:141], v[172:173], v[100:101], v[140:141] op_sel_hi:[1,0,1]
  v_pk_fma_f32 v[142:143], v[174:175], v[100:101], v[142:143] op_sel_hi:[1,0,1]
  v_pk_fma_f32 v[144:145], v[176:177], v[100:101], v[144:145] op_sel_hi:[1,0,1]
  v_pk_fma_f32 v[146:147], v[178:179], v[100:101], v[146:147] op_sel_hi:[1,0,1]
  v_pk_fma_f32 v[148:149], v[180:181], v[100:101], v[148:149] op_sel_hi:[1,0,1]
  v_pk_fma_f32 v[150:151], v[182:183], v[100:101], v[150:151] op_sel_hi:[1,0,1]
  v_pk_fma_f32 v[152:153], v[184:185], v[100:101], v[152:153] op_sel_hi:[1,0,1]
  v_pk_fma_f32 v[154:155], v[186:187], v[100:101], v[154:155] op_sel_hi:[1,0,1]
  v_pk_fma_f32 v[156:157], v[188:189], v[100:101], v[156:157] op_sel_hi:[1,0,1]
  v_pk_fma_f32 v[158:159], v[190:191], v[100:101], v[158:159] op_sel_hi:[1,0,1]
  s_cmp_eq_u32 s80, 2
  s_cbranch_scc1 L_finish
  buffer_store_dwordx4 v[128:131], v105, s[32:35], 0 offen offset:0 sc1
  buffer_store_dwordx4 v[132:135], v105, s[32:35], 0 offen offset:1024 sc1
  buffer_store_dwordx4 v[136:139], v105, s[32:35], 0 offen offset:2048 sc1
  buffer_store_dwordx4 v[140:143], v105, s[32:35], 0 offen offset:3072 sc1
  buffer_store_dwordx4 v[144:147], v105, s[32:35], s40 offen offset:0 sc1
  buffer_store_dwordx4 v[148:151], v105, s[32:35], s40 offen offset:1024 sc1
  buffer_store_dwordx4 v[152:155], v105, s[32:35], s40 offen offset:2048 sc1
  buffer_store_dwordx4 v[156:159], v105, s[32:35], s40 offen offset:3072 sc1
  buffer_store_dwordx2 v[42:43], v104, s[32:35], s41 offen sc1
  s_waitcnt vmcnt(0)
  s_barrier
  s_cmp_eq_u32 s3, 0
  s_cbranch_scc0 L_exit
  s_lshl_b32 s99, 16, s88
  s_atomic_add s99, s[96:97], 0x0 glc
  s_waitcnt lgkmcnt(0)
  s_branch L_exit
L_finish:
  s_cmp_eq_u32 s48, 0
  s_cbranch_scc0 L_have_partner
  s_cmp_eq_u32 s3, 3
  s_cbranch_scc0 L_wait_lds
L_wait_pub:
  s_mov_b32 s99, 0
  s_atomic_add s99, s[96:97], 0x0 glc
  s_waitcnt lgkmcnt(0)
  s_lshr_b32 s99, s99, s88
  s_and_b32 s53, s99, 16
  s_cbranch_scc1 L_pub_seen
  s_sleep 1
  s_branch L_wait_pub
L_pub_seen:
  v_mov_b32 v95, 1
  s_mov_b64 exec, 1
  ds_write_b32 v109, v95 offset:8
  s_mov_b64 exec, -1
  s_branch L_pub_go
L_wait_lds:
L_w_pub:
  ds_read_b32 v95, v109 offset:8
  s_waitcnt lgkmcnt(0)
  v_readfirstlane_b32 s53, v95
  s_nop 0
  s_cmp_lg_u32 s53, 0
  s_cbranch_scc1 L_g_pub
  s_sleep 1
  s_branch L_w_pub
L_g_pub:
L_pub_go:
  buffer_load_dwordx4 v[8:11], v105, s[36:39], 0 offen offset:0 sc1
  buffer_load_dwordx4 v[12:15], v105, s[36:39], 0 offen offset:1024 sc1
  buffer_load_dwordx4 v[16:19], v105, s[36:39], 0 offen offset:2048 sc1
  buffer_load_dwordx4 v[20:23], v105, s[36:39], 0 offen offset:3072 sc1
  buffer_load_dwordx4 v[24:27], v105, s[36:39], s40 offen offset:0 sc1
  buffer_load_dwordx4 v[28:31], v105, s[36:39], s40 offen offset:1024 sc1
  buffer_load_dwordx4 v[32:35], v105, s[36:39], s40 offen offset:2048 sc1
  buffer_load_dwordx4 v[36:39], v105, s[36:39], s40 offen offset:3072 sc1
  buffer_load_dwordx2 v[40:41], v104, s[36:39], s41 offen sc1
L_have_partner:
  s_waitcnt vmcnt(0)
  v_max_f32 v45, v42, v40
  v_sub_f32 v98, v42, v45
  v_sub_f32 v100, v40, v45
  v_exp_f32 v98, v98
  v_exp_f32 v100, v100
  s_nop 0
  v_mul_f32 v43, v43, v98
  v_fma_f32 v43, v41, v100, v43
  v_rcp_f32 v43, v43
  s_nop 0
  v_mul_f32 v98, v98, v43
  v_mul_f32 v100, v100, v43
  v_pk_mul_f32 v[128:129], v[128:129], v[98:99] op_sel_hi:[1,0]
  v_pk_mul_f32 v[130:131], v[130:131], v[98:99] op_sel_hi:[1,0]
  v_pk_mul_f32 v[132:133], v[132:133], v[98:99] op_sel_hi:[1,0]
  v_pk_mul_f32 v[134:135], v[134:135], v[98:99] op_sel_hi:[1,0]
  v_pk_mul_f32 v[136:137], v[136:137], v[98:99] op_sel_hi:[1,0]
  v_pk_mul_f32 v[138:139], v[138:139], v[98:99] op_sel_hi:[1,0]
  v_pk_mul_f32 v[140:141], v[140:141], v[98:99] op_sel_hi:[1,0]
  v_pk_mul_f32 v[142:143], v[142:143], v[98:99] op_sel_hi:[1,0]
  v_pk_fma_f32 v[128:129], v[8:9], v[100:101], v[128:129] op_sel_hi:[1,0,1]
  v_pk_fma_f32 v[130:131], v[10:11], v[100:101], v[130:131] op_sel_hi:[1,0,1]
  v_pk_fma_f32 v[132:133], v[12:13], v[100:101], v[132:133] op_sel_hi:[1,0,1]
  v_pk_fma_f32 v[134:135], v[14:15], v[100:101], v[134:135] op_sel_hi:[1,0,1]
  v_pk_fma_f32 v[136:137], v[16:17], v[100:101], v[136:137] op_sel_hi:[1,0,1]
  v_pk_fma_f32 v[138:139], v[18:19], v[100:101], v[138:139] op_sel_hi:[1,0,1]
  v_pk_fma_f32 v[140:141], v[20:21], v[100:101], v[140:141] op_sel_hi:[1,0,1]
  v_pk_fma_f32 v[142:143], v[22:23], v[100:101], v[142:143] op_sel_hi:[1,0,1]
  v_cvt_pk_bf16_f32 v192, v128, v129
  v_cvt_pk_bf16_f32 v193, v130, v131
  v_cvt_pk_bf16_f32 v194, v132, v133
  v_cvt_pk_bf16_f32 v195, v134, v135
  v_cvt_pk_bf16_f32 v196, v136, v137
  v_cvt_pk_bf16_f32 v197, v138, v139
  v_cvt_pk_bf16_f32 v198, v140, v141
  v_cvt_pk_bf16_f32 v199, v142, v143
  s_nop 1
  v_permlane32_swap_b32 v192, v194
  v_permlane32_swap_b32 v193, v195
  v_permlane32_swap_b32 v196, v198
  v_permlane32_swap_b32 v197, v199
  buffer_store_dwordx4 v[192:195], v108, s[92:95], 0 offen offset:0
  buffer_store_dwordx4 v[196:199], v108, s[92:95], 0 offen offset:32
  v_pk_mul_f32 v[144:145], v[144:145], v[98:99] op_sel_hi:[1,0]
  v_pk_mul_f32 v[146:147], v[146:147], v[98:99] op_sel_hi:[1,0]
  v_pk_mul_f32 v[148:149], v[148:149], v[98:99] op_sel_hi:[1,0]
  v_pk_mul_f32 v[150:151], v[150:151], v[98:99] op_sel_hi:[1,0]
  v_pk_mul_f32 v[152:153], v[152:153], v[98:99] op_sel_hi:[1,0]
  v_pk_mul_f32 v[154:155], v[154:155], v[98:99] op_sel_hi:[1,0]
  v_pk_mul_f32 v[156:157], v[156:157], v[98:99] op_sel_hi:[1,0]
  v_pk_mul_f32 v[158:159], v[158:159], v[98:99] op_sel_hi:[1,0]
  v_pk_fma_f32 v[144:145], v[24:25], v[100:101], v[144:145] op_sel_hi:[1,0,1]
  v_pk_fma_f32 v[146:147], v[26:27], v[100:101], v[146:147] op_sel_hi:[1,0,1]
  v_pk_fma_f32 v[148:149], v[28:29], v[100:101], v[148:149] op_sel_hi:[1,0,1]
  v_pk_fma_f32 v[150:151], v[30:31], v[100:101], v[150:151] op_sel_hi:[1,0,1]
  v_pk_fma_f32 v[152:153], v[32:33], v[100:101], v[152:153] op_sel_hi:[1,0,1]
  v_pk_fma_f32 v[154:155], v[34:35], v[100:101], v[154:155] op_sel_hi:[1,0,1]
  v_pk_fma_f32 v[156:157], v[36:37], v[100:101], v[156:157] op_sel_hi:[1,0,1]
  v_pk_fma_f32 v[158:159], v[38:39], v[100:101], v[158:159] op_sel_hi:[1,0,1]
  v_cvt_pk_bf16_f32 v200, v144, v145
  v_cvt_pk_bf16_f32 v201, v146, v147
  v_cvt_pk_bf16_f32 v202, v148, v149
  v_cvt_pk_bf16_f32 v203, v150, v151
  v_cvt_pk_bf16_f32 v204, v152, v153
  v_cvt_pk_bf16_f32 v205, v154, v155
  v_cvt_pk_bf16_f32 v206, v156, v157
  v_cvt_pk_bf16_f32 v207, v158, v159
  s_nop 1
  v_permlane32_swap_b32 v200, v202
  v_permlane32_swap_b32 v201, v203
  v_permlane32_swap_b32 v204, v206
  v_permlane32_swap_b32 v205, v207
  buffer_store_dwordx4 v[200:203], v108, s[92:95], 0 offen offset:64
  buffer_store_dwordx4 v[204:207], v108, s[92:95], 0 offen offset:96
L_exit:
L_end:
  s_endpgm
.section .rodata,"a"
.p2align 6
.amdhsa_kernel standalone__tree_speculative_verify_tree_attention_over_candidate_token_tree__sampling_kernel
  .amdhsa_next_free_vgpr 512
  .amdhsa_next_free_sgpr 102
  .amdhsa_accum_offset 256
  .amdhsa_group_segment_fixed_size 0
  .amdhsa_kernarg_size 72
  .amdhsa_user_sgpr_count 2
  .amdhsa_user_sgpr_kernarg_segment_ptr 1
  .amdhsa_system_sgpr_workgroup_id_x 1
  .amdhsa_float_denorm_mode_32 3
.end_amdhsa_kernel
```
